```python
import torch

def _softmax(x, axis=-1):
    return torch.softmax(x, dim=axis)
def _gelu(x):
    return torch.nn.functional.gelu(x, approximate="tanh")
def _silu(x):
    return torch.nn.functional.silu(x)
def _sigmoid(x):
    return torch.sigmoid(x)
def _layernorm(x, axis=-1, eps=1e-5):
    m = x.mean(dim=axis, keepdim=True)
    v = x.var(dim=axis, keepdim=True, unbiased=False)
    return (x - m) / torch.sqrt(v + eps)
def _scatter_add(tgt, idx, src, axis=0):
    return tgt.clone().index_add_(axis, idx, src)
def _segment_sum(src, seg, n):
    out = torch.zeros((n,) + src.shape[1:], dtype=src.dtype)
    return out.index_add_(0, seg, src)
def _pad(x, pw):
    flat = tuple(v for pair in reversed(pw) for v in pair)
    return torch.nn.functional.pad(x, flat)

kernel_name = 'parallel_sum__ssm_conv_s4d__moe_arch_mod__prompt'

def setup_inputs():

    _w = (lambda a: (lambda t: t.to(torch.bfloat16) if t.is_floating_point() else t)(torch.as_tensor(a)))
    def _A_setup():
        Bsz, L, D, N = 1, 2048, 1024, 128
        return {
            "u": _w((lambda *s: torch.randn(*s, dtype=torch.bfloat16) * 0.05)(Bsz, L, D)),
            "log_A_real": _w((lambda *s: torch.randn(*s, dtype=torch.bfloat16) * 3.2)(D, N) * 0.5),
            "A_imag": _w((lambda *s: torch.randn(*s, dtype=torch.bfloat16) * 0.2)(D, N) * 3.14),
            "C_real": _w((lambda *s: torch.randn(*s, dtype=torch.bfloat16) * 3.2)(D, N) / N ** 0.5),
            "C_imag": _w((lambda *s: torch.randn(*s, dtype=torch.bfloat16) * 3.2)(D, N) / N ** 0.5),
            "log_dt": _w((lambda *s: torch.randn(*s, dtype=torch.bfloat16) * 0.2)(D) * 0.5 - 4.0),
            "D_skip": _w((lambda *s: torch.randn(*s, dtype=torch.bfloat16) * 0.4)(D)),
        }
    _A_in = _A_setup()

    def _B_setup():
        B, S, D, F, C = 1, 2048, 1024, 3584, 1
        return {
            "x": _w((lambda *s: torch.randn(*s, dtype=torch.bfloat16) * 0.05)(B, S, D)),
            "w_r": _w((lambda *s: torch.randn(*s, dtype=torch.bfloat16) * 0.05)(D)),
            "w_gate": _w((lambda *s: torch.randn(*s, dtype=torch.bfloat16) * 0.05)(D, F)),
            "w_up": _w((lambda *s: torch.randn(*s, dtype=torch.bfloat16) * 0.05)(D, F)),
            "w_down": _w((lambda *s: torch.randn(*s, dtype=torch.bfloat16) * 0.05)(F, D)),
        }
    _B_in = _B_setup()

    return {
        "A_u": _A_in["u"],
        "A_log_A_real": _A_in["log_A_real"],
        "A_A_imag": _A_in["A_imag"],
        "A_C_real": _A_in["C_real"],
        "A_C_imag": _A_in["C_imag"],
        "A_log_dt": _A_in["log_dt"],
        "A_D_skip": _A_in["D_skip"],
        "B_x": _B_in["x"],
        "B_w_r": _B_in["w_r"],
        "B_w_gate": _B_in["w_gate"],
        "B_w_up": _B_in["w_up"],
        "B_w_down": _B_in["w_down"],
    }

def reference(A_u, A_log_A_real, A_A_imag, A_C_real, A_C_imag, A_log_dt, A_D_skip, B_x, B_w_r, B_w_gate, B_w_up, B_w_down):
    def _A_ref(u, log_A_real, A_imag, C_real, C_imag, log_dt, D_skip):
        L = u.shape[1]
        dt = torch.exp(log_dt)
        A = -torch.exp(log_A_real) + 1j * A_imag
        C = (C_real + 1j * C_imag) * dt[:, None]
        pos = (lambda x, dt: x.to(dt))(torch.arange(L), log_dt.dtype)
        P = torch.exp((A * dt[:, None])[:, :, None] * pos[None, None, :])
        K = 2.0 * torch.einsum("dn,dnl->dl", C, P).real
        L2 = 2 * L
        u_t = (lambda x, *d: x.permute(*d))(u, 0, 2, 1)
        Kf = (lambda x, *a, **k: torch.fft.rfft(x.float(), *a, **k))(K, L2)
        Uf = (lambda x, *a, **k: torch.fft.rfft(x.float(), *a, **k))(u_t, L2)
        y = (lambda x, *a, **k: torch.fft.irfft(x, *a, **k).to(torch.bfloat16))(Uf * Kf[None, :, :], L2)[:, :, :L]
        y = (lambda x, *d: x.permute(*d))(y, 0, 2, 1)
        return y + u * D_skip[None, None, :]

    def _B_ref(x, w_r, w_gate, w_up, w_down):
        B, S, D = x.shape
        C = 1
        r = x @ w_r
        idx = torch.argsort(-r, axis=-1)[:, :C]
        idx_e = (lambda x, n, axis: torch.repeat_interleave(x, n, dim=axis))(idx.reshape(B, C, 1), D, axis=2)
        x_sel = (lambda x, i, axis: torch.take_along_dim(x, i, dim=axis))(x, idx_e, axis=1)
        g = _silu(x_sel @ w_gate)
        u = x_sel @ w_up
        y = (g * u) @ w_down
        r_sel = _sigmoid((lambda x, i, axis: torch.take_along_dim(x, i, dim=axis))(r, idx, axis=1))
        y = y * r_sel.reshape(B, C, 1)
        b_off = (torch.arange(B) * S).reshape(B, 1)
        flat_idx = (idx + b_off).reshape(B * C)
        zero = (x * 0.0).reshape(B * S, D)
        upd = _scatter_add(zero, flat_idx, y.reshape(B * C, D), axis=0)
        return x + upd.reshape(B, S, D)

    x = A_u
    xn = _layernorm(x, axis=-1)
    return x + _A_ref(xn, A_log_A_real, A_A_imag, A_C_real, A_C_imag, A_log_dt, A_D_skip) + _B_ref(xn, B_w_r, B_w_gate, B_w_up, B_w_down)
```

```asm
; @launch kernel=k1_kernel grid=(256,1,1) block=(512,1,1) lds=139408
; @launch kernel=k2_kernel grid=(256,1,1) block=(768,1,1) lds=139264
; @launch kernel=k3_kernel grid=(288,1,1) block=(256,1,1) lds=4096
.amdgcn_target "amdgcn-amd-amdhsa--gfx950"
.text
.globl k1_kernel
.p2align 8
.type k1_kernel,@function
k1_kernel:
  s_cmp_ge_u32 s2, 256
  s_cbranch_scc1 K1_END
  s_load_dwordx2 s[20:21], s[0:1], 8
  s_load_dwordx2 s[24:25], s[0:1], 16
  s_load_dwordx2 s[28:29], s[0:1], 24
  s_load_dwordx2 s[32:33], s[0:1], 32
  s_load_dwordx2 s[36:37], s[0:1], 40
  s_load_dwordx2 s[8:9], s[0:1], 0
  s_load_dwordx2 s[16:17], s[0:1], 64
  s_load_dwordx2 s[12:13], s[0:1], 112
  s_load_dwordx2 s[40:41], s[0:1], 72
  s_load_dwordx2 s[44:45], s[0:1], 80
  s_load_dwordx2 s[48:49], s[0:1], 88
  s_load_dwordx2 s[64:65], s[0:1], 96
  s_load_dwordx2 s[68:69], s[0:1], 48
  v_lshrrev_b32 v1, 6, v0
  v_and_b32 v2, 63, v0
  s_getpc_b64 s[62:63]
K1_PC:
  s_sub_u32 s62, s62, K1_PC-k1_kernel
  s_subb_u32 s63, s63, 0
  s_bfe_u32 s4, s2, 0x20003
  s_lshl_b32 s4, s4, 13
  v_lshlrev_b32 v247, 10, v1
  v_lshl_add_u32 v247, v2, 7, v247
  v_add_u32 v247, s4, v247
  v_min_u32 v247, CODE_END-k1_kernel-4, v247
  s_mov_b64 exec, 0xff
  global_load_dword v248, v247, s[62:63]
  s_mov_b64 exec, -1
  v_readfirstlane_b32 s3, v1
  s_mov_b32 s22, 262144
  s_mov_b32 s23, 0x20000
  s_mov_b32 s26, 262144
  s_mov_b32 s27, 0x20000
  s_mov_b32 s30, 262144
  s_mov_b32 s31, 0x20000
  s_mov_b32 s34, 262144
  s_mov_b32 s35, 0x20000
  s_mov_b32 s38, 2048
  s_mov_b32 s39, 0x20000
  s_mov_b32 s10, 4194304
  s_mov_b32 s11, 0x20000
  s_mov_b32 s18, 2048
  s_mov_b32 s19, 0x20000
  s_cmp_ge_u32 s3, 4
  s_cbranch_scc1 K1_LNLD
  s_and_b32 s4, s2, 7
  s_lshl_b32 s4, s4, 5
  s_lshr_b32 s5, s2, 3
  s_add_u32 s4, s4, s5
  s_lshl_b32 s4, s4, 2
  s_add_u32 s4, s4, s3
  s_lshl_b32 s5, s4, 8
  s_lshl_b32 s6, s4, 1
  v_lshlrev_b32 v3, 2, v2
  v_mov_b32 v9, 0
  s_waitcnt lgkmcnt(0)
  buffer_load_dword v4, v3, s[20:23], s5 offen
  buffer_load_dword v5, v3, s[24:27], s5 offen
  buffer_load_dword v6, v3, s[28:31], s5 offen
  buffer_load_dword v7, v3, s[32:35], s5 offen
  buffer_load_ushort v8, v9, s[36:39], s6 offen
  v_mov_b32 v3, 139392
  ds_write_b32 v3, v9
  ds_write_b32 v3, v9 offset:4
  ds_write_b32 v3, v9 offset:8
  s_waitcnt lgkmcnt(0)
  s_barrier
  s_branch K1_KGEN
K1_LNLD:
  s_sub_u32 s3, s3, 4
  s_lshl_b32 s4, s2, 3
  s_lshl_b32 s5, s3, 1
  s_add_u32 s4, s4, s5
  s_lshl_b32 s5, s4, 11
  v_lshlrev_b32 v3, 4, v2
  s_waitcnt lgkmcnt(0)
  buffer_load_dwordx4 v[4:7], v3, s[8:11], s5 offen
  buffer_load_dwordx4 v[8:11], v3, s[8:11], s5 offen offset:1024
  buffer_load_dwordx4 v[12:15], v3, s[8:11], s5 offen offset:2048
  buffer_load_dwordx4 v[16:19], v3, s[8:11], s5 offen offset:3072
  buffer_load_dwordx4 v[20:23], v3, s[16:19], 0 offen
  buffer_load_dwordx4 v[24:27], v3, s[16:19], 0 offen offset:1024
  s_barrier
  s_branch K1_LN
K1_KGEN:
  s_mov_b32 s14, 25165824
  s_mov_b32 s15, 0x20000
  s_mov_b32 s42, 7340032
  s_mov_b32 s43, 0x20000
  s_mov_b32 s46, 7340032
  s_mov_b32 s47, 0x20000
  s_mov_b32 s50, 7340032
  s_mov_b32 s51, 0x20000
  s_mov_b32 s55, 0x36eca570
  s_and_b32 s56, s2, 7
  s_lshr_b32 s57, s2, 3
  v_mul_u32_u24 v241, 9363, v0
  v_lshrrev_b32 v241, 16, v241
  v_mul_u32_u24 v242, 7, v241
  v_sub_u32 v242, v0, v242
  v_mul_u32_u24 v241, 7168, v241
  v_lshl_add_u32 v241, v242, 7, v241
  s_mul_i32 s58, s57, 229376
  s_mul_i32 s59, s56, 896
  s_add_u32 s61, s58, s59
  v_mov_b32 v243, 0x7ffffff0
  v_lshlrev_b32 v242, 7, v0
  v_cmp_gt_u32 vcc, 224, v0
  s_nop 1
  v_cndmask_b32 v241, v243, v241, vcc
  v_cndmask_b32 v242, v243, v242, vcc
  s_mul_i32 s60, s56, 448
  s_mul_i32 s59, s57, 14
  s_add_u32 s60, s60, s59
  s_lshl_b32 s60, s60, 11
  s_waitcnt vmcnt(0)
  v_lshlrev_b32 v20, 16, v4
  v_and_b32 v21, 0xffff0000, v4
  v_lshlrev_b32 v22, 16, v5
  v_and_b32 v23, 0xffff0000, v5
  v_lshlrev_b32 v24, 16, v6
  v_and_b32 v25, 0xffff0000, v6
  v_lshlrev_b32 v26, 16, v7
  v_and_b32 v27, 0xffff0000, v7
  v_lshlrev_b32 v18, 16, v8
  s_mov_b32 s56, 0xc3000000
  v_mov_b32 v17, 0x43000000
  v_med3_f32 v18, v18, s56, v17
  v_med3_f32 v20, v20, s56, v17
  v_med3_f32 v21, v21, s56, v17
  v_mul_f32 v10, 0x3fb8aa00, v18
  v_rndne_f32 v11, v10
  v_sub_f32 v10, v10, v11
  v_fma_f32 v10, v18, s55, v10
  v_exp_f32 v10, v10
  v_cvt_i32_f32 v11, v11
  v_ldexp_f32 v18, v10, v11
  v_mul_f32 v12, 0x3fb8aa00, v20
  v_rndne_f32 v13, v12
  v_sub_f32 v12, v12, v13
  v_fma_f32 v12, v20, s55, v12
  v_exp_f32 v12, v12
  v_cvt_i32_f32 v13, v13
  v_ldexp_f32 v20, v12, v13
  v_mul_f32 v14, 0x3fb8aa00, v21
  v_rndne_f32 v15, v14
  v_sub_f32 v14, v14, v15
  v_fma_f32 v14, v21, s55, v14
  v_exp_f32 v14, v14
  v_cvt_i32_f32 v15, v15
  v_ldexp_f32 v21, v14, v15
  v_cvt_pk_bf16_f32 v10, v18, v18
  v_cvt_pk_bf16_f32 v11, v20, v21
  v_lshlrev_b32 v18, 16, v10
  v_lshlrev_b32 v20, 16, v11
  v_and_b32 v21, 0xffff0000, v11
  v_mul_f32 v20, v20, v18
  v_mul_f32 v22, v22, v18
  v_mul_f32 v24, v24, v18
  v_mul_f32 v26, v26, v18
  v_mul_f32 v20, 0xbfb8aa3b, v20
  v_mul_f32 v21, v21, v18
  v_mul_f32 v23, v23, v18
  v_mul_f32 v25, v25, v18
  v_mul_f32 v27, v27, v18
  v_mul_f32 v21, 0xbfb8aa3b, v21
  v_max_f32 v28, |v24|, |v25|
  v_max3_f32 v28, |v26|, |v27|, v28
  s_nop 1
  v_max_f32_dpp v28, v28, v28 row_shr:1 row_mask:0xf bank_mask:0xf bound_ctrl:0
  s_nop 1
  v_max_f32_dpp v28, v28, v28 row_shr:2 row_mask:0xf bank_mask:0xf bound_ctrl:0
  s_nop 1
  v_max_f32_dpp v28, v28, v28 row_shr:4 row_mask:0xf bank_mask:0xf bound_ctrl:0
  s_nop 1
  v_max_f32_dpp v28, v28, v28 row_shr:8 row_mask:0xf bank_mask:0xf bound_ctrl:0
  s_nop 1
  v_max_f32_dpp v28, v28, v28 row_bcast:15 row_mask:0xa bank_mask:0xf
  s_nop 1
  v_max_f32_dpp v28, v28, v28 row_bcast:31 row_mask:0xc bank_mask:0xf
  s_mov_b32 s56, 0x3e22f983
  s_mov_b32 s57, 0x31dc9c88
  v_mul_f32 v30, s56, v22
  v_fma_f32 v32, v22, s56, -v30
  v_fma_f32 v32, v22, s57, v32
  v_mul_f32 v31, s56, v23
  v_fma_f32 v33, v23, s56, -v31
  v_fma_f32 v33, v23, s57, v33
  v_frexp_exp_i32_f32 v28, v28
  s_nop 0
  v_readlane_b32 s58, v28, 63
  s_nop 0
  s_max_i32 s58, s58, -100
  s_min_i32 s58, s58, 120
  s_sub_i32 s59, 7, s58
  s_sub_i32 s58, s58, 6
  v_ldexp_f32 v34, v24, s59
  v_ldexp_f32 v36, v26, s59
  v_ldexp_f32 v35, v25, s59
  v_ldexp_f32 v37, v27, s59
  v_mul_f32 v10, 0x3f800000, v20
  v_mul_f32 v11, 0x3f800000, v30
  v_exp_f32 v10, v10
  v_fract_f32 v11, v11
  v_mul_f32 v12, 0x3f800000, v32
  v_add_f32 v11, v11, v12
  v_cos_f32 v12, v11
  v_sin_f32 v13, v11
  v_mul_f32 v14, 0x3f800000, v21
  v_mul_f32 v15, 0x3f800000, v31
  v_exp_f32 v14, v14
  v_fract_f32 v15, v15
  v_mul_f32 v16, 0x3f800000, v33
  v_add_f32 v15, v15, v16
  v_cos_f32 v16, v15
  v_sin_f32 v17, v15
  v_mul_f32 v38, v10, v12
  v_mul_f32 v40, v10, v13
  v_mul_f32 v39, v14, v16
  v_mul_f32 v41, v14, v17
  v_mul_f32 v10, 0x41000000, v20
  v_mul_f32 v11, 0x41000000, v30
  v_exp_f32 v10, v10
  v_fract_f32 v11, v11
  v_mul_f32 v12, 0x41000000, v32
  v_add_f32 v11, v11, v12
  v_cos_f32 v12, v11
  v_sin_f32 v13, v11
  v_mul_f32 v14, 0x41000000, v21
  v_mul_f32 v15, 0x41000000, v31
  v_exp_f32 v14, v14
  v_fract_f32 v15, v15
  v_mul_f32 v16, 0x41000000, v33
  v_add_f32 v15, v15, v16
  v_cos_f32 v16, v15
  v_sin_f32 v17, v15
  v_mul_f32 v42, v10, v12
  v_mul_f32 v44, v10, v13
  v_mul_f32 v43, v14, v16
  v_mul_f32 v45, v14, v17
  v_mul_f32 v10, 0x43000000, v20
  v_mul_f32 v11, 0x43000000, v30
  v_exp_f32 v10, v10
  v_fract_f32 v11, v11
  v_mul_f32 v12, 0x43000000, v32
  v_add_f32 v11, v11, v12
  v_cos_f32 v12, v11
  v_sin_f32 v13, v11
  v_mul_f32 v14, 0x43000000, v21
  v_mul_f32 v15, 0x43000000, v31
  v_exp_f32 v14, v14
  v_fract_f32 v15, v15
  v_mul_f32 v16, 0x43000000, v33
  v_add_f32 v15, v15, v16
  v_cos_f32 v16, v15
  v_sin_f32 v17, v15
  v_mul_f32 v46, v10, v12
  v_mul_f32 v48, v10, v13
  v_mul_f32 v47, v14, v16
  v_mul_f32 v49, v14, v17
  s_mul_i32 s54, s3, 30624
  v_lshlrev_b32 v50, 3, v2
  v_add_u32 v50, s54, v50
  v_mov_b32 v68, 0x3c00
  v_mov_b32 v69, 0x3c00
  ds_write_b64 v50, v[68:69] offset:0
  v_cvt_pk_f16_f32 v60, v42, v44
  v_cvt_pk_f16_f32 v61, v43, v45
  ds_write_b64 v50, v[60:61] offset:528
  v_cvt_pk_f16_f32 v62, v34, -v36
  v_cvt_pk_f16_f32 v63, v35, -v37
  ds_write_b64 v50, v[62:63] offset:8448
  v_pk_mul_f32 v[52:53], v[44:45], v[44:45]
  v_pk_mul_f32 v[54:55], v[44:45], v[42:43]
  v_pk_fma_f32 v[98:99], v[42:43], v[42:43], v[52:53] neg_lo:[0,0,1] neg_hi:[0,0,1]
  v_pk_fma_f32 v[100:101], v[42:43], v[44:45], v[54:55]
  v_pk_mul_f32 v[56:57], v[36:37], v[40:41]
  v_pk_mul_f32 v[58:59], v[36:37], v[38:39]
  v_pk_fma_f32 v[70:71], v[34:35], v[38:39], v[56:57] neg_lo:[0,0,1] neg_hi:[0,0,1]
  v_pk_fma_f32 v[72:73], v[34:35], v[40:41], v[58:59]
  v_cvt_pk_f16_f32 v64, v70, -v72
  v_cvt_pk_f16_f32 v65, v71, -v73
  ds_write_b64 v50, v[64:65] offset:8976
  v_cvt_pk_f16_f32 v66, v98, v100
  v_cvt_pk_f16_f32 v67, v99, v101
  ds_write_b64 v50, v[66:67] offset:1056
  v_pk_mul_f32 v[52:53], v[100:101], v[44:45]
  v_pk_mul_f32 v[54:55], v[100:101], v[42:43]
  v_pk_fma_f32 v[102:103], v[98:99], v[42:43], v[52:53] neg_lo:[0,0,1] neg_hi:[0,0,1]
  v_pk_fma_f32 v[104:105], v[98:99], v[44:45], v[54:55]
  v_pk_mul_f32 v[56:57], v[72:73], v[40:41]
  v_pk_mul_f32 v[58:59], v[72:73], v[38:39]
  v_pk_fma_f32 v[74:75], v[70:71], v[38:39], v[56:57] neg_lo:[0,0,1] neg_hi:[0,0,1]
  v_pk_fma_f32 v[76:77], v[70:71], v[40:41], v[58:59]
  v_cvt_pk_f16_f32 v60, v74, -v76
  v_cvt_pk_f16_f32 v61, v75, -v77
  ds_write_b64 v50, v[60:61] offset:9504
  v_cvt_pk_f16_f32 v62, v102, v104
  v_cvt_pk_f16_f32 v63, v103, v105
  ds_write_b64 v50, v[62:63] offset:1584
  v_pk_mul_f32 v[52:53], v[104:105], v[44:45]
  v_pk_mul_f32 v[54:55], v[104:105], v[42:43]
  v_pk_fma_f32 v[98:99], v[102:103], v[42:43], v[52:53] neg_lo:[0,0,1] neg_hi:[0,0,1]
  v_pk_fma_f32 v[100:101], v[102:103], v[44:45], v[54:55]
  v_pk_mul_f32 v[56:57], v[76:77], v[40:41]
  v_pk_mul_f32 v[58:59], v[76:77], v[38:39]
  v_pk_fma_f32 v[78:79], v[74:75], v[38:39], v[56:57] neg_lo:[0,0,1] neg_hi:[0,0,1]
  v_pk_fma_f32 v[80:81], v[74:75], v[40:41], v[58:59]
  v_cvt_pk_f16_f32 v64, v78, -v80
  v_cvt_pk_f16_f32 v65, v79, -v81
  ds_write_b64 v50, v[64:65] offset:10032
  v_cvt_pk_f16_f32 v66, v98, v100
  v_cvt_pk_f16_f32 v67, v99, v101
  ds_write_b64 v50, v[66:67] offset:2112
  v_pk_mul_f32 v[52:53], v[100:101], v[44:45]
  v_pk_mul_f32 v[54:55], v[100:101], v[42:43]
  v_pk_fma_f32 v[102:103], v[98:99], v[42:43], v[52:53] neg_lo:[0,0,1] neg_hi:[0,0,1]
  v_pk_fma_f32 v[104:105], v[98:99], v[44:45], v[54:55]
  v_pk_mul_f32 v[56:57], v[80:81], v[40:41]
  v_pk_mul_f32 v[58:59], v[80:81], v[38:39]
  v_pk_fma_f32 v[82:83], v[78:79], v[38:39], v[56:57] neg_lo:[0,0,1] neg_hi:[0,0,1]
  v_pk_fma_f32 v[84:85], v[78:79], v[40:41], v[58:59]
  v_cvt_pk_f16_f32 v60, v82, -v84
  v_cvt_pk_f16_f32 v61, v83, -v85
  ds_write_b64 v50, v[60:61] offset:10560
  v_cvt_pk_f16_f32 v62, v102, v104
  v_cvt_pk_f16_f32 v63, v103, v105
  ds_write_b64 v50, v[62:63] offset:2640
  v_pk_mul_f32 v[52:53], v[104:105], v[44:45]
  v_pk_mul_f32 v[54:55], v[104:105], v[42:43]
  v_pk_fma_f32 v[98:99], v[102:103], v[42:43], v[52:53] neg_lo:[0,0,1] neg_hi:[0,0,1]
  v_pk_fma_f32 v[100:101], v[102:103], v[44:45], v[54:55]
  v_pk_mul_f32 v[56:57], v[84:85], v[40:41]
  v_pk_mul_f32 v[58:59], v[84:85], v[38:39]
  v_pk_fma_f32 v[86:87], v[82:83], v[38:39], v[56:57] neg_lo:[0,0,1] neg_hi:[0,0,1]
  v_pk_fma_f32 v[88:89], v[82:83], v[40:41], v[58:59]
  v_cvt_pk_f16_f32 v64, v86, -v88
  v_cvt_pk_f16_f32 v65, v87, -v89
  ds_write_b64 v50, v[64:65] offset:11088
  v_cvt_pk_f16_f32 v66, v98, v100
  v_cvt_pk_f16_f32 v67, v99, v101
  ds_write_b64 v50, v[66:67] offset:3168
  v_pk_mul_f32 v[52:53], v[100:101], v[44:45]
  v_pk_mul_f32 v[54:55], v[100:101], v[42:43]
  v_pk_fma_f32 v[102:103], v[98:99], v[42:43], v[52:53] neg_lo:[0,0,1] neg_hi:[0,0,1]
  v_pk_fma_f32 v[104:105], v[98:99], v[44:45], v[54:55]
  v_pk_mul_f32 v[56:57], v[88:89], v[40:41]
  v_pk_mul_f32 v[58:59], v[88:89], v[38:39]
  v_pk_fma_f32 v[90:91], v[86:87], v[38:39], v[56:57] neg_lo:[0,0,1] neg_hi:[0,0,1]
  v_pk_fma_f32 v[92:93], v[86:87], v[40:41], v[58:59]
  v_cvt_pk_f16_f32 v60, v90, -v92
  v_cvt_pk_f16_f32 v61, v91, -v93
  ds_write_b64 v50, v[60:61] offset:11616
  v_cvt_pk_f16_f32 v62, v102, v104
  v_cvt_pk_f16_f32 v63, v103, v105
  ds_write_b64 v50, v[62:63] offset:3696
  v_pk_mul_f32 v[52:53], v[104:105], v[44:45]
  v_pk_mul_f32 v[54:55], v[104:105], v[42:43]
  v_pk_fma_f32 v[98:99], v[102:103], v[42:43], v[52:53] neg_lo:[0,0,1] neg_hi:[0,0,1]
  v_pk_fma_f32 v[100:101], v[102:103], v[44:45], v[54:55]
  v_pk_mul_f32 v[56:57], v[92:93], v[40:41]
  v_pk_mul_f32 v[58:59], v[92:93], v[38:39]
  v_pk_fma_f32 v[94:95], v[90:91], v[38:39], v[56:57] neg_lo:[0,0,1] neg_hi:[0,0,1]
  v_pk_fma_f32 v[96:97], v[90:91], v[40:41], v[58:59]
  v_cvt_pk_f16_f32 v64, v94, -v96
  v_cvt_pk_f16_f32 v65, v95, -v97
  ds_write_b64 v50, v[64:65] offset:12144
  v_cvt_pk_f16_f32 v66, v98, v100
  v_cvt_pk_f16_f32 v67, v99, v101
  ds_write_b64 v50, v[66:67] offset:4224
  v_pk_mul_f32 v[52:53], v[100:101], v[44:45]
  v_pk_mul_f32 v[54:55], v[100:101], v[42:43]
  v_pk_fma_f32 v[102:103], v[98:99], v[42:43], v[52:53] neg_lo:[0,0,1] neg_hi:[0,0,1]
  v_pk_fma_f32 v[104:105], v[98:99], v[44:45], v[54:55]
  v_cvt_pk_f16_f32 v60, v102, v104
  v_cvt_pk_f16_f32 v61, v103, v105
  ds_write_b64 v50, v[60:61] offset:4752
  v_pk_mul_f32 v[56:57], v[104:105], v[44:45]
  v_pk_mul_f32 v[58:59], v[104:105], v[42:43]
  v_pk_fma_f32 v[98:99], v[102:103], v[42:43], v[56:57] neg_lo:[0,0,1] neg_hi:[0,0,1]
  v_pk_fma_f32 v[100:101], v[102:103], v[44:45], v[58:59]
  v_cvt_pk_f16_f32 v62, v98, v100
  v_cvt_pk_f16_f32 v63, v99, v101
  ds_write_b64 v50, v[62:63] offset:5280
  v_pk_mul_f32 v[52:53], v[100:101], v[44:45]
  v_pk_mul_f32 v[54:55], v[100:101], v[42:43]
  v_pk_fma_f32 v[102:103], v[98:99], v[42:43], v[52:53] neg_lo:[0,0,1] neg_hi:[0,0,1]
  v_pk_fma_f32 v[104:105], v[98:99], v[44:45], v[54:55]
  v_cvt_pk_f16_f32 v64, v102, v104
  v_cvt_pk_f16_f32 v65, v103, v105
  ds_write_b64 v50, v[64:65] offset:5808
  v_pk_mul_f32 v[56:57], v[104:105], v[44:45]
  v_pk_mul_f32 v[58:59], v[104:105], v[42:43]
  v_pk_fma_f32 v[98:99], v[102:103], v[42:43], v[56:57] neg_lo:[0,0,1] neg_hi:[0,0,1]
  v_pk_fma_f32 v[100:101], v[102:103], v[44:45], v[58:59]
  v_cvt_pk_f16_f32 v66, v98, v100
  v_cvt_pk_f16_f32 v67, v99, v101
  ds_write_b64 v50, v[66:67] offset:6336
  v_pk_mul_f32 v[52:53], v[100:101], v[44:45]
  v_pk_mul_f32 v[54:55], v[100:101], v[42:43]
  v_pk_fma_f32 v[102:103], v[98:99], v[42:43], v[52:53] neg_lo:[0,0,1] neg_hi:[0,0,1]
  v_pk_fma_f32 v[104:105], v[98:99], v[44:45], v[54:55]
  v_cvt_pk_f16_f32 v60, v102, v104
  v_cvt_pk_f16_f32 v61, v103, v105
  ds_write_b64 v50, v[60:61] offset:6864
  v_pk_mul_f32 v[56:57], v[104:105], v[44:45]
  v_pk_mul_f32 v[58:59], v[104:105], v[42:43]
  v_pk_fma_f32 v[98:99], v[102:103], v[42:43], v[56:57] neg_lo:[0,0,1] neg_hi:[0,0,1]
  v_pk_fma_f32 v[100:101], v[102:103], v[44:45], v[58:59]
  v_cvt_pk_f16_f32 v62, v98, v100
  v_cvt_pk_f16_f32 v63, v99, v101
  ds_write_b64 v50, v[62:63] offset:7392
  v_pk_mul_f32 v[52:53], v[100:101], v[44:45]
  v_pk_mul_f32 v[54:55], v[100:101], v[42:43]
  v_pk_fma_f32 v[102:103], v[98:99], v[42:43], v[52:53] neg_lo:[0,0,1] neg_hi:[0,0,1]
  v_pk_fma_f32 v[104:105], v[98:99], v[44:45], v[54:55]
  v_cvt_pk_f16_f32 v64, v102, v104
  v_cvt_pk_f16_f32 v65, v103, v105
  ds_write_b64 v50, v[64:65] offset:7920
  v_pk_mul_f32 v[56:57], v[36:37], v[48:49]
  v_pk_mul_f32 v[58:59], v[36:37], v[46:47]
  v_pk_fma_f32 v[106:107], v[34:35], v[46:47], v[56:57] neg_lo:[0,0,1] neg_hi:[0,0,1]
  v_pk_fma_f32 v[108:109], v[34:35], v[48:49], v[58:59]
  v_pk_mul_f32 v[52:53], v[72:73], v[48:49]
  v_pk_mul_f32 v[54:55], v[72:73], v[46:47]
  v_pk_fma_f32 v[110:111], v[70:71], v[46:47], v[52:53] neg_lo:[0,0,1] neg_hi:[0,0,1]
  v_pk_fma_f32 v[112:113], v[70:71], v[48:49], v[54:55]
  v_pk_mul_f32 v[56:57], v[76:77], v[48:49]
  v_pk_mul_f32 v[58:59], v[76:77], v[46:47]
  v_pk_fma_f32 v[114:115], v[74:75], v[46:47], v[56:57] neg_lo:[0,0,1] neg_hi:[0,0,1]
  v_pk_fma_f32 v[116:117], v[74:75], v[48:49], v[58:59]
  v_pk_mul_f32 v[52:53], v[80:81], v[48:49]
  v_pk_mul_f32 v[54:55], v[80:81], v[46:47]
  v_pk_fma_f32 v[118:119], v[78:79], v[46:47], v[52:53] neg_lo:[0,0,1] neg_hi:[0,0,1]
  v_pk_fma_f32 v[120:121], v[78:79], v[48:49], v[54:55]
  v_pk_mul_f32 v[56:57], v[84:85], v[48:49]
  v_pk_mul_f32 v[58:59], v[84:85], v[46:47]
  v_pk_fma_f32 v[122:123], v[82:83], v[46:47], v[56:57] neg_lo:[0,0,1] neg_hi:[0,0,1]
  v_pk_fma_f32 v[124:125], v[82:83], v[48:49], v[58:59]
  v_pk_mul_f32 v[52:53], v[88:89], v[48:49]
  v_pk_mul_f32 v[54:55], v[88:89], v[46:47]
  v_pk_fma_f32 v[126:127], v[86:87], v[46:47], v[52:53] neg_lo:[0,0,1] neg_hi:[0,0,1]
  v_pk_fma_f32 v[128:129], v[86:87], v[48:49], v[54:55]
  v_pk_mul_f32 v[56:57], v[92:93], v[48:49]
  v_pk_mul_f32 v[58:59], v[92:93], v[46:47]
  v_pk_fma_f32 v[130:131], v[90:91], v[46:47], v[56:57] neg_lo:[0,0,1] neg_hi:[0,0,1]
  v_pk_fma_f32 v[132:133], v[90:91], v[48:49], v[58:59]
  v_pk_mul_f32 v[52:53], v[96:97], v[48:49]
  v_pk_mul_f32 v[54:55], v[96:97], v[46:47]
  v_pk_fma_f32 v[134:135], v[94:95], v[46:47], v[52:53] neg_lo:[0,0,1] neg_hi:[0,0,1]
  v_pk_fma_f32 v[136:137], v[94:95], v[48:49], v[54:55]
  v_cvt_pk_f16_f32 v66, v106, -v108
  v_cvt_pk_f16_f32 v67, v107, -v109
  ds_write_b64 v50, v[66:67] offset:12672
  v_cvt_pk_f16_f32 v60, v110, -v112
  v_cvt_pk_f16_f32 v61, v111, -v113
  ds_write_b64 v50, v[60:61] offset:13200
  v_cvt_pk_f16_f32 v62, v114, -v116
  v_cvt_pk_f16_f32 v63, v115, -v117
  ds_write_b64 v50, v[62:63] offset:13728
  v_cvt_pk_f16_f32 v64, v118, -v120
  v_cvt_pk_f16_f32 v65, v119, -v121
  ds_write_b64 v50, v[64:65] offset:14256
  v_cvt_pk_f16_f32 v66, v122, -v124
  v_cvt_pk_f16_f32 v67, v123, -v125
  ds_write_b64 v50, v[66:67] offset:14784
  v_cvt_pk_f16_f32 v60, v126, -v128
  v_cvt_pk_f16_f32 v61, v127, -v129
  ds_write_b64 v50, v[60:61] offset:15312
  v_cvt_pk_f16_f32 v62, v130, -v132
  v_cvt_pk_f16_f32 v63, v131, -v133
  ds_write_b64 v50, v[62:63] offset:15840
  v_cvt_pk_f16_f32 v64, v134, -v136
  v_cvt_pk_f16_f32 v65, v135, -v137
  ds_write_b64 v50, v[64:65] offset:16368
  v_pk_mul_f32 v[56:57], v[108:109], v[48:49]
  v_pk_mul_f32 v[58:59], v[108:109], v[46:47]
  v_pk_fma_f32 v[34:35], v[106:107], v[46:47], v[56:57] neg_lo:[0,0,1] neg_hi:[0,0,1]
  v_pk_fma_f32 v[36:37], v[106:107], v[48:49], v[58:59]
  v_pk_mul_f32 v[52:53], v[116:117], v[48:49]
  v_pk_mul_f32 v[54:55], v[116:117], v[46:47]
  v_pk_fma_f32 v[74:75], v[114:115], v[46:47], v[52:53] neg_lo:[0,0,1] neg_hi:[0,0,1]
  v_pk_fma_f32 v[76:77], v[114:115], v[48:49], v[54:55]
  v_pk_mul_f32 v[56:57], v[124:125], v[48:49]
  v_pk_mul_f32 v[58:59], v[124:125], v[46:47]
  v_pk_fma_f32 v[82:83], v[122:123], v[46:47], v[56:57] neg_lo:[0,0,1] neg_hi:[0,0,1]
  v_pk_fma_f32 v[84:85], v[122:123], v[48:49], v[58:59]
  v_pk_mul_f32 v[52:53], v[132:133], v[48:49]
  v_pk_mul_f32 v[54:55], v[132:133], v[46:47]
  v_pk_fma_f32 v[90:91], v[130:131], v[46:47], v[52:53] neg_lo:[0,0,1] neg_hi:[0,0,1]
  v_pk_fma_f32 v[92:93], v[130:131], v[48:49], v[54:55]
  v_pk_mul_f32 v[56:57], v[36:37], v[44:45]
  v_pk_mul_f32 v[58:59], v[36:37], v[42:43]
  v_pk_fma_f32 v[70:71], v[34:35], v[42:43], v[56:57] neg_lo:[0,0,1] neg_hi:[0,0,1]
  v_pk_fma_f32 v[72:73], v[34:35], v[44:45], v[58:59]
  v_cvt_pk_f16_f32 v66, v34, -v36
  v_cvt_pk_f16_f32 v67, v35, -v37
  ds_write_b64 v50, v[66:67] offset:16896
  v_cvt_pk_f16_f32 v60, v74, -v76
  v_cvt_pk_f16_f32 v61, v75, -v77
  ds_write_b64 v50, v[60:61] offset:17424
  v_cvt_pk_f16_f32 v62, v82, -v84
  v_cvt_pk_f16_f32 v63, v83, -v85
  ds_write_b64 v50, v[62:63] offset:17952
  v_cvt_pk_f16_f32 v64, v90, -v92
  v_cvt_pk_f16_f32 v65, v91, -v93
  ds_write_b64 v50, v[64:65] offset:18480
  v_cvt_pk_f16_f32 v66, v70, -v72
  v_cvt_pk_f16_f32 v67, v71, -v73
  ds_write_b64 v50, v[66:67] offset:19008
  v_pk_mul_f32 v[52:53], v[36:37], v[48:49]
  v_pk_mul_f32 v[54:55], v[36:37], v[46:47]
  v_pk_fma_f32 v[106:107], v[34:35], v[46:47], v[52:53] neg_lo:[0,0,1] neg_hi:[0,0,1]
  v_pk_fma_f32 v[108:109], v[34:35], v[48:49], v[54:55]
  v_pk_mul_f32 v[56:57], v[76:77], v[48:49]
  v_pk_mul_f32 v[58:59], v[76:77], v[46:47]
  v_pk_fma_f32 v[114:115], v[74:75], v[46:47], v[56:57] neg_lo:[0,0,1] neg_hi:[0,0,1]
  v_pk_fma_f32 v[116:117], v[74:75], v[48:49], v[58:59]
  v_pk_mul_f32 v[52:53], v[84:85], v[48:49]
  v_pk_mul_f32 v[54:55], v[84:85], v[46:47]
  v_pk_fma_f32 v[122:123], v[82:83], v[46:47], v[52:53] neg_lo:[0,0,1] neg_hi:[0,0,1]
  v_pk_fma_f32 v[124:125], v[82:83], v[48:49], v[54:55]
  v_pk_mul_f32 v[56:57], v[92:93], v[48:49]
  v_pk_mul_f32 v[58:59], v[92:93], v[46:47]
  v_pk_fma_f32 v[130:131], v[90:91], v[46:47], v[56:57] neg_lo:[0,0,1] neg_hi:[0,0,1]
  v_pk_fma_f32 v[132:133], v[90:91], v[48:49], v[58:59]
  v_pk_mul_f32 v[52:53], v[72:73], v[48:49]
  v_pk_mul_f32 v[54:55], v[72:73], v[46:47]
  v_pk_fma_f32 v[110:111], v[70:71], v[46:47], v[52:53] neg_lo:[0,0,1] neg_hi:[0,0,1]
  v_pk_fma_f32 v[112:113], v[70:71], v[48:49], v[54:55]
  v_cvt_pk_f16_f32 v60, v106, -v108
  v_cvt_pk_f16_f32 v61, v107, -v109
  ds_write_b64 v50, v[60:61] offset:19536
  v_cvt_pk_f16_f32 v62, v114, -v116
  v_cvt_pk_f16_f32 v63, v115, -v117
  ds_write_b64 v50, v[62:63] offset:20064
  v_cvt_pk_f16_f32 v64, v122, -v124
  v_cvt_pk_f16_f32 v65, v123, -v125
  ds_write_b64 v50, v[64:65] offset:20592
  v_cvt_pk_f16_f32 v66, v130, -v132
  v_cvt_pk_f16_f32 v67, v131, -v133
  ds_write_b64 v50, v[66:67] offset:21120
  v_cvt_pk_f16_f32 v60, v110, -v112
  v_cvt_pk_f16_f32 v61, v111, -v113
  ds_write_b64 v50, v[60:61] offset:21648
  v_pk_mul_f32 v[56:57], v[124:125], v[48:49]
  v_pk_mul_f32 v[58:59], v[124:125], v[46:47]
  v_pk_fma_f32 v[74:75], v[122:123], v[46:47], v[56:57] neg_lo:[0,0,1] neg_hi:[0,0,1]
  v_pk_fma_f32 v[76:77], v[122:123], v[48:49], v[58:59]
  v_pk_mul_f32 v[52:53], v[112:113], v[48:49]
  v_pk_mul_f32 v[54:55], v[112:113], v[46:47]
  v_pk_fma_f32 v[78:79], v[110:111], v[46:47], v[52:53] neg_lo:[0,0,1] neg_hi:[0,0,1]
  v_pk_fma_f32 v[80:81], v[110:111], v[48:49], v[54:55]
  v_cvt_pk_f16_f32 v62, v74, -v76
  v_cvt_pk_f16_f32 v63, v75, -v77
  ds_write_b64 v50, v[62:63] offset:22176
  v_cvt_pk_f16_f32 v64, v78, -v80
  v_cvt_pk_f16_f32 v65, v79, -v81
  ds_write_b64 v50, v[64:65] offset:22704
  v_pk_mul_f32 v[56:57], v[76:77], v[48:49]
  v_pk_mul_f32 v[58:59], v[76:77], v[46:47]
  v_pk_fma_f32 v[82:83], v[74:75], v[46:47], v[56:57] neg_lo:[0,0,1] neg_hi:[0,0,1]
  v_pk_fma_f32 v[84:85], v[74:75], v[48:49], v[58:59]
  v_pk_mul_f32 v[52:53], v[80:81], v[48:49]
  v_pk_mul_f32 v[54:55], v[80:81], v[46:47]
  v_pk_fma_f32 v[86:87], v[78:79], v[46:47], v[52:53] neg_lo:[0,0,1] neg_hi:[0,0,1]
  v_pk_fma_f32 v[88:89], v[78:79], v[48:49], v[54:55]
  v_cvt_pk_f16_f32 v66, v82, -v84
  v_cvt_pk_f16_f32 v67, v83, -v85
  ds_write_b64 v50, v[66:67] offset:23232
  v_cvt_pk_f16_f32 v60, v86, -v88
  v_cvt_pk_f16_f32 v61, v87, -v89
  ds_write_b64 v50, v[60:61] offset:23760
  v_pk_mul_f32 v[56:57], v[84:85], v[48:49]
  v_pk_mul_f32 v[58:59], v[84:85], v[46:47]
  v_pk_fma_f32 v[74:75], v[82:83], v[46:47], v[56:57] neg_lo:[0,0,1] neg_hi:[0,0,1]
  v_pk_fma_f32 v[76:77], v[82:83], v[48:49], v[58:59]
  v_pk_mul_f32 v[52:53], v[88:89], v[48:49]
  v_pk_mul_f32 v[54:55], v[88:89], v[46:47]
  v_pk_fma_f32 v[78:79], v[86:87], v[46:47], v[52:53] neg_lo:[0,0,1] neg_hi:[0,0,1]
  v_pk_fma_f32 v[80:81], v[86:87], v[48:49], v[54:55]
  v_cvt_pk_f16_f32 v62, v74, -v76
  v_cvt_pk_f16_f32 v63, v75, -v77
  ds_write_b64 v50, v[62:63] offset:24288
  v_cvt_pk_f16_f32 v64, v78, -v80
  v_cvt_pk_f16_f32 v65, v79, -v81
  ds_write_b64 v50, v[64:65] offset:24816
  v_pk_mul_f32 v[56:57], v[76:77], v[48:49]
  v_pk_mul_f32 v[58:59], v[76:77], v[46:47]
  v_pk_fma_f32 v[82:83], v[74:75], v[46:47], v[56:57] neg_lo:[0,0,1] neg_hi:[0,0,1]
  v_pk_fma_f32 v[84:85], v[74:75], v[48:49], v[58:59]
  v_pk_mul_f32 v[52:53], v[80:81], v[48:49]
  v_pk_mul_f32 v[54:55], v[80:81], v[46:47]
  v_pk_fma_f32 v[86:87], v[78:79], v[46:47], v[52:53] neg_lo:[0,0,1] neg_hi:[0,0,1]
  v_pk_fma_f32 v[88:89], v[78:79], v[48:49], v[54:55]
  v_cvt_pk_f16_f32 v66, v82, -v84
  v_cvt_pk_f16_f32 v67, v83, -v85
  ds_write_b64 v50, v[66:67] offset:25344
  v_cvt_pk_f16_f32 v60, v86, -v88
  v_cvt_pk_f16_f32 v61, v87, -v89
  ds_write_b64 v50, v[60:61] offset:25872
  v_pk_mul_f32 v[56:57], v[48:49], v[48:49]
  v_pk_mul_f32 v[58:59], v[48:49], v[46:47]
  v_pk_fma_f32 v[106:107], v[46:47], v[46:47], v[56:57] neg_lo:[0,0,1] neg_hi:[0,0,1]
  v_pk_fma_f32 v[108:109], v[46:47], v[48:49], v[58:59]
  v_pk_mul_f32 v[52:53], v[88:89], v[48:49]
  v_pk_mul_f32 v[54:55], v[88:89], v[46:47]
  v_pk_fma_f32 v[114:115], v[86:87], v[46:47], v[52:53] neg_lo:[0,0,1] neg_hi:[0,0,1]
  v_pk_fma_f32 v[116:117], v[86:87], v[48:49], v[54:55]
  v_pk_mul_f32 v[56:57], v[88:89], v[108:109]
  v_pk_mul_f32 v[58:59], v[88:89], v[106:107]
  v_pk_fma_f32 v[118:119], v[86:87], v[106:107], v[56:57] neg_lo:[0,0,1] neg_hi:[0,0,1]
  v_pk_fma_f32 v[120:121], v[86:87], v[108:109], v[58:59]
  v_cvt_pk_f16_f32 v62, v114, -v116
  v_cvt_pk_f16_f32 v63, v115, -v117
  ds_write_b64 v50, v[62:63] offset:26400
  v_cvt_pk_f16_f32 v64, v118, -v120
  v_cvt_pk_f16_f32 v65, v119, -v121
  ds_write_b64 v50, v[64:65] offset:26928
  v_pk_mul_f32 v[52:53], v[116:117], v[108:109]
  v_pk_mul_f32 v[54:55], v[116:117], v[106:107]
  v_pk_fma_f32 v[126:127], v[114:115], v[106:107], v[52:53] neg_lo:[0,0,1] neg_hi:[0,0,1]
  v_pk_fma_f32 v[128:129], v[114:115], v[108:109], v[54:55]
  v_pk_mul_f32 v[56:57], v[120:121], v[108:109]
  v_pk_mul_f32 v[58:59], v[120:121], v[106:107]
  v_pk_fma_f32 v[130:131], v[118:119], v[106:107], v[56:57] neg_lo:[0,0,1] neg_hi:[0,0,1]
  v_pk_fma_f32 v[132:133], v[118:119], v[108:109], v[58:59]
  v_cvt_pk_f16_f32 v66, v126, -v128
  v_cvt_pk_f16_f32 v67, v127, -v129
  ds_write_b64 v50, v[66:67] offset:27456
  v_cvt_pk_f16_f32 v60, v130, -v132
  v_cvt_pk_f16_f32 v61, v131, -v133
  ds_write_b64 v50, v[60:61] offset:27984
  v_pk_mul_f32 v[52:53], v[128:129], v[108:109]
  v_pk_mul_f32 v[54:55], v[128:129], v[106:107]
  v_pk_fma_f32 v[114:115], v[126:127], v[106:107], v[52:53] neg_lo:[0,0,1] neg_hi:[0,0,1]
  v_pk_fma_f32 v[116:117], v[126:127], v[108:109], v[54:55]
  v_pk_mul_f32 v[56:57], v[132:133], v[108:109]
  v_pk_mul_f32 v[58:59], v[132:133], v[106:107]
  v_pk_fma_f32 v[118:119], v[130:131], v[106:107], v[56:57] neg_lo:[0,0,1] neg_hi:[0,0,1]
  v_pk_fma_f32 v[120:121], v[130:131], v[108:109], v[58:59]
  v_cvt_pk_f16_f32 v62, v114, -v116
  v_cvt_pk_f16_f32 v63, v115, -v117
  ds_write_b64 v50, v[62:63] offset:28512
  v_cvt_pk_f16_f32 v64, v118, -v120
  v_cvt_pk_f16_f32 v65, v119, -v121
  ds_write_b64 v50, v[64:65] offset:29040
  v_pk_mul_f32 v[52:53], v[116:117], v[108:109]
  v_pk_mul_f32 v[54:55], v[116:117], v[106:107]
  v_pk_fma_f32 v[126:127], v[114:115], v[106:107], v[52:53] neg_lo:[0,0,1] neg_hi:[0,0,1]
  v_pk_fma_f32 v[128:129], v[114:115], v[108:109], v[54:55]
  v_pk_mul_f32 v[56:57], v[120:121], v[108:109]
  v_pk_mul_f32 v[58:59], v[120:121], v[106:107]
  v_pk_fma_f32 v[130:131], v[118:119], v[106:107], v[56:57] neg_lo:[0,0,1] neg_hi:[0,0,1]
  v_pk_fma_f32 v[132:133], v[118:119], v[108:109], v[58:59]
  v_cvt_pk_f16_f32 v66, v126, -v128
  v_cvt_pk_f16_f32 v67, v127, -v129
  ds_write_b64 v50, v[66:67] offset:29568
  v_cvt_pk_f16_f32 v60, v130, -v132
  v_cvt_pk_f16_f32 v61, v131, -v133
  ds_write_b64 v50, v[60:61] offset:30096
  v_and_b32 v138, 15, v2
  v_lshrrev_b32 v139, 4, v2
  v_lshlrev_b32 v10, 4, v139
  v_add_u32 v10, s54, v10
  v_mul_u32_u24 v11, 528, v138
  v_add_u32 v140, v10, v11
  v_add_u32 v141, 8448, v140
  v_add_u32 v143, 22176, v140
  v_and_b32 v12, 7, v138
  v_lshlrev_b32 v12, 2, v12
  s_mov_b32 s56, 0x43222100
  v_lshrrev_b32 v12, v12, s56
  v_and_b32 v12, 15, v12
  v_lshrrev_b32 v13, 3, v138
  v_mul_u32_u24 v13, 5, v13
  v_add3_u32 v12, v12, v13, 32
  v_mul_u32_u24 v12, 528, v12
  v_add_u32 v142, v10, v12
  s_waitcnt lgkmcnt(0)
  ds_read_b128 v[144:147], v140 offset:0
  ds_read_b128 v[148:151], v140 offset:64
  ds_read_b128 v[152:155], v140 offset:128
  ds_read_b128 v[156:159], v140 offset:192
  ds_read_b128 v[160:163], v140 offset:256
  ds_read_b128 v[164:167], v140 offset:320
  ds_read_b128 v[168:171], v140 offset:384
  ds_read_b128 v[172:175], v140 offset:448
  ds_read_b128 v[176:179], v141 offset:0
  ds_read_b128 v[180:183], v141 offset:64
  ds_read_b128 v[184:187], v141 offset:128
  ds_read_b128 v[188:191], v141 offset:192
  ds_read_b128 v[192:195], v141 offset:256
  ds_read_b128 v[196:199], v141 offset:320
  ds_read_b128 v[200:203], v141 offset:384
  ds_read_b128 v[204:207], v141 offset:448
  s_waitcnt lgkmcnt(7)
  v_mfma_f32_16x16x32_f16 v[208:211], v[176:179], v[144:147], 0
  s_waitcnt lgkmcnt(6)
  v_mfma_f32_16x16x32_f16 v[208:211], v[180:183], v[148:151], v[208:211]
  s_waitcnt lgkmcnt(5)
  v_mfma_f32_16x16x32_f16 v[208:211], v[184:187], v[152:155], v[208:211]
  s_waitcnt lgkmcnt(4)
  v_mfma_f32_16x16x32_f16 v[208:211], v[188:191], v[156:159], v[208:211]
  s_waitcnt lgkmcnt(3)
  v_mfma_f32_16x16x32_f16 v[208:211], v[192:195], v[160:163], v[208:211]
  s_waitcnt lgkmcnt(2)
  v_mfma_f32_16x16x32_f16 v[208:211], v[196:199], v[164:167], v[208:211]
  s_waitcnt lgkmcnt(1)
  v_mfma_f32_16x16x32_f16 v[208:211], v[200:203], v[168:171], v[208:211]
  s_waitcnt lgkmcnt(0)
  v_mfma_f32_16x16x32_f16 v[208:211], v[204:207], v[172:175], v[208:211]
  ds_read_b128 v[34:37], v142 offset:0
  ds_read_b128 v[70:73], v142 offset:64
  ds_read_b128 v[74:77], v142 offset:128
  ds_read_b128 v[78:81], v142 offset:192
  ds_read_b128 v[82:85], v142 offset:256
  ds_read_b128 v[86:89], v142 offset:320
  ds_read_b128 v[90:93], v142 offset:384
  ds_read_b128 v[94:97], v142 offset:448
  ds_read_b128 v[106:109], v143 offset:0
  ds_read_b128 v[110:113], v143 offset:64
  ds_read_b128 v[114:117], v143 offset:128
  ds_read_b128 v[118:121], v143 offset:192
  ds_read_b128 v[122:125], v143 offset:256
  ds_read_b128 v[126:129], v143 offset:320
  ds_read_b128 v[130:133], v143 offset:384
  ds_read_b128 v[134:137], v143 offset:448
  s_waitcnt lgkmcnt(15)
  v_mfma_f32_16x16x32_f16 v[212:215], v[34:37], v[144:147], 0
  s_waitcnt lgkmcnt(14)
  v_mfma_f32_16x16x32_f16 v[212:215], v[70:73], v[148:151], v[212:215]
  s_waitcnt lgkmcnt(13)
  v_mfma_f32_16x16x32_f16 v[212:215], v[74:77], v[152:155], v[212:215]
  s_waitcnt lgkmcnt(12)
  v_mfma_f32_16x16x32_f16 v[212:215], v[78:81], v[156:159], v[212:215]
  s_waitcnt lgkmcnt(11)
  v_mfma_f32_16x16x32_f16 v[212:215], v[82:85], v[160:163], v[212:215]
  s_waitcnt lgkmcnt(10)
  v_mfma_f32_16x16x32_f16 v[212:215], v[86:89], v[164:167], v[212:215]
  s_waitcnt lgkmcnt(9)
  v_mfma_f32_16x16x32_f16 v[212:215], v[90:93], v[168:171], v[212:215]
  s_waitcnt lgkmcnt(8)
  v_mfma_f32_16x16x32_f16 v[212:215], v[94:97], v[172:175], v[212:215]
  s_waitcnt lgkmcnt(7)
  v_mfma_f32_16x16x32_f16 v[220:223], v[144:147], v[106:109], 0
  s_waitcnt lgkmcnt(6)
  v_mfma_f32_16x16x32_f16 v[220:223], v[148:151], v[110:113], v[220:223]
  s_waitcnt lgkmcnt(5)
  v_mfma_f32_16x16x32_f16 v[220:223], v[152:155], v[114:117], v[220:223]
  s_waitcnt lgkmcnt(4)
  v_mfma_f32_16x16x32_f16 v[220:223], v[156:159], v[118:121], v[220:223]
  s_waitcnt lgkmcnt(3)
  v_mfma_f32_16x16x32_f16 v[220:223], v[160:163], v[122:125], v[220:223]
  s_waitcnt lgkmcnt(2)
  v_mfma_f32_16x16x32_f16 v[220:223], v[164:167], v[126:129], v[220:223]
  s_waitcnt lgkmcnt(1)
  v_mfma_f32_16x16x32_f16 v[220:223], v[168:171], v[130:133], v[220:223]
  s_waitcnt lgkmcnt(0)
  v_mfma_f32_16x16x32_f16 v[220:223], v[172:175], v[134:137], v[220:223]
  s_lshl_b32 s5, s4, 11
  s_add_u32 s5, s5, 4194304
  v_lshlrev_b32 v17, 4, v2
  v_add_u32 v140, s54, v17
  v_mov_b32 v184, 0
  v_mov_b32 v185, 0
  v_mov_b32 v186, 0
  v_mov_b32 v187, 0
  ds_write_b128 v140, v[184:187]
  ds_write_b128 v140, v[184:187] offset:1024
  v_lshlrev_b32 v10, 4, v138
  v_and_b32 v11, 1, v139
  v_lshl_add_u32 v10, v11, 3, v10
  v_lshrrev_b32 v11, 1, v139
  v_lshl_add_u32 v10, v11, 8, v10
  v_add_u32 v10, s54, v10
  v_lshrrev_b32 v11, 1, v138
  v_lshlrev_b32 v11, 4, v11
  v_and_b32 v12, 1, v138
  v_mul_u32_u24 v12, 112, v12
  v_add3_u32 v11, v11, v12, s54
  v_lshl_add_u32 v11, v139, 2, v11
  v_lshlrev_b32 v12, 4, v138
  v_lshl_add_u32 v12, v139, 2, v12
  v_add_u32 v12, s54, v12
  v_mov_b32 v16, 1.0
  v_ldexp_f32 v16, v16, s58
  v_cvt_pk_f16_f32 v176, v208, v209
  v_cvt_pk_f16_f32 v177, v210, v211
  ds_write_b64 v10, v[176:177] offset:64
  v_cvt_pk_f16_f32 v178, v212, v213
  v_cvt_pk_f16_f32 v179, v214, v215
  ds_write_b64 v10, v[178:179] offset:576
  v_cvt_pk_f16_f32 v180, v220, v222
  v_cvt_pk_f16_f32 v181, v221, v223
  v_cvt_pk_f16_f32 v182, v215, v215
  v_lshrrev_b32 v183, 16, v182
  s_mov_b32 s56, 0x00ff00ff
  s_mov_b32 s57, 0x00ff00ff
  s_mov_b64 exec, s[56:57]
  ds_write_b32 v11, v180 offset:1152
  ds_write_b32 v11, v181 offset:1376
  s_not_b64 exec, exec
  ds_write_b32 v12, v180 offset:1472
  ds_write_b32 v12, v181 offset:1648
  s_mov_b32 s56, 0
  s_mov_b32 s57, 0x80000000
  s_mov_b64 exec, s[56:57]
  ds_write_b64 v10, v[182:183] offset:584
  s_mov_b64 exec, 1
  ds_write_b32 v140, v16 offset:0
  s_mov_b64 exec, -1
  ds_read_b128 v[188:191], v140
  ds_read_b128 v[192:195], v140 offset:1024
  s_waitcnt lgkmcnt(1)
  buffer_store_dwordx4 v[188:191], v17, s[12:15], s5 offen sc1
  s_waitcnt lgkmcnt(0)
  buffer_store_dwordx4 v[192:195], v17, s[12:15], s5 offen offset:1024 sc1
  s_cmp_lg_u32 s3, 0
  s_cbranch_scc1 K1_NOCLR
  s_lshl_b32 s56, s2, 10
  s_add_u32 s56, s56, 8454144
  buffer_store_dwordx4 v[184:187], v17, s[12:15], s56 offen sc1
K1_NOCLR:
  s_endpgm
K1_LN:
  s_mov_b32 s14, 25165824
  s_mov_b32 s15, 0x20000
  s_mov_b32 s42, 7340032
  s_mov_b32 s43, 0x20000
  s_mov_b32 s46, 7340032
  s_mov_b32 s47, 0x20000
  s_mov_b32 s50, 7340032
  s_mov_b32 s51, 0x20000
  v_subrev_u32 v0, 256, v0
  s_and_b32 s56, s2, 7
  s_lshr_b32 s57, s2, 3
  v_mul_u32_u24 v241, 9363, v0
  v_lshrrev_b32 v241, 16, v241
  v_mul_u32_u24 v242, 7, v241
  v_sub_u32 v242, v0, v242
  v_mul_u32_u24 v241, 7168, v241
  v_lshl_add_u32 v241, v242, 7, v241
  s_mul_i32 s58, s57, 229376
  s_mul_i32 s59, s56, 896
  s_add_u32 s61, s58, s59
  v_mov_b32 v243, 0x7ffffff0
  v_lshlrev_b32 v242, 7, v0
  v_cmp_gt_u32 vcc, 224, v0
  s_nop 1
  v_cndmask_b32 v241, v243, v241, vcc
  v_cndmask_b32 v242, v243, v242, vcc
  s_mul_i32 s60, s56, 448
  s_mul_i32 s59, s57, 14
  s_add_u32 s60, s60, s59
  s_lshl_b32 s60, s60, 11
  buffer_load_dword v244, v241, s[40:43], s61 offen offset:0
  buffer_load_dword v245, v241, s[44:47], s61 offen offset:0
  s_mul_i32 s52, s3, 4224
  v_add_u32 v117, s52, v3
  v_bfe_u32 v118, v2, 2, 2
  v_mul_u32_u24 v118, 2112, v118
  v_lshrrev_b32 v119, 4, v2
  v_lshl_add_u32 v118, v119, 5, v118
  v_and_b32 v119, 3, v2
  v_lshl_add_u32 v118, v119, 3, v118
  s_lshl_b32 s52, s3, 9
  v_add_u32 v118, s52, v118
  v_lshrrev_b32 v1, 3, v2
  v_lshlrev_b32 v1, 15, v1
  v_and_b32 v119, 7, v2
  v_lshl_add_u32 v1, v119, 4, v1
  s_lshl_b32 s70, s3, 20
  s_lshl_b32 s53, s2, 7
  s_add_u32 s70, s70, s53
  s_add_u32 s70, s70, 16777216
  s_add_u32 s72, s70, 4194304
  v_mov_b32 v116, 139392
  v_mov_b32 v119, 1
  v_add_u32 v117, 122496, v117
  v_add_u32 v118, 122496, v118
  s_waitcnt vmcnt(4)
  ds_write_b128 v117, v[4:7]
  ds_write_b128 v117, v[8:11] offset:1024
  ds_write_b128 v117, v[12:15] offset:2112
  ds_write_b128 v117, v[16:19] offset:3136
  s_mov_b64 exec, 1
  ds_add_u32 v116, v119 offset:8
  s_mov_b64 exec, -1
  v_lshlrev_b32 v32, 16, v4
  v_and_b32 v33, 0xffff0000, v4
  v_lshlrev_b32 v34, 16, v5
  v_and_b32 v35, 0xffff0000, v5
  v_lshlrev_b32 v36, 16, v6
  v_and_b32 v37, 0xffff0000, v6
  v_lshlrev_b32 v38, 16, v7
  v_and_b32 v39, 0xffff0000, v7
  v_lshlrev_b32 v40, 16, v8
  v_and_b32 v41, 0xffff0000, v8
  v_lshlrev_b32 v42, 16, v9
  v_and_b32 v43, 0xffff0000, v9
  v_lshlrev_b32 v44, 16, v10
  v_and_b32 v45, 0xffff0000, v10
  v_lshlrev_b32 v46, 16, v11
  v_and_b32 v47, 0xffff0000, v11
  v_lshlrev_b32 v48, 16, v12
  v_and_b32 v49, 0xffff0000, v12
  v_lshlrev_b32 v50, 16, v13
  v_and_b32 v51, 0xffff0000, v13
  v_lshlrev_b32 v52, 16, v14
  v_and_b32 v53, 0xffff0000, v14
  v_lshlrev_b32 v54, 16, v15
  v_and_b32 v55, 0xffff0000, v15
  v_lshlrev_b32 v56, 16, v16
  v_and_b32 v57, 0xffff0000, v16
  v_lshlrev_b32 v58, 16, v17
  v_and_b32 v59, 0xffff0000, v17
  v_lshlrev_b32 v60, 16, v18
  v_and_b32 v61, 0xffff0000, v18
  v_lshlrev_b32 v62, 16, v19
  v_and_b32 v63, 0xffff0000, v19
  v_add_f32 v66, v32, v33
  v_add_f32 v67, v34, v35
  v_add_f32 v68, v36, v37
  v_add_f32 v69, v38, v39
  v_add_f32 v70, v40, v41
  v_add_f32 v71, v42, v43
  v_add_f32 v72, v44, v45
  v_add_f32 v73, v46, v47
  v_add_f32 v74, v48, v49
  v_add_f32 v75, v50, v51
  v_add_f32 v76, v52, v53
  v_add_f32 v77, v54, v55
  v_add_f32 v78, v56, v57
  v_add_f32 v79, v58, v59
  v_add_f32 v80, v60, v61
  v_add_f32 v81, v62, v63
  v_add_f32 v66, v66, v70
  v_add_f32 v67, v67, v71
  v_add_f32 v68, v68, v72
  v_add_f32 v69, v69, v73
  v_add_f32 v74, v74, v78
  v_add_f32 v75, v75, v79
  v_add_f32 v76, v76, v80
  v_add_f32 v77, v77, v81
  v_add_f32 v66, v66, v68
  v_add_f32 v67, v67, v69
  v_add_f32 v74, v74, v76
  v_add_f32 v75, v75, v77
  v_add_f32 v64, v66, v67
  v_add_f32 v65, v74, v75
K1_SPIN:
  ds_read_b32 v115, v116 offset:8
  s_waitcnt lgkmcnt(0)
  v_readfirstlane_b32 s71, v115
  s_nop 1
  s_cmp_lt_u32 s71, 4
  s_cbranch_scc1 K1_SPIN
  ds_read_b64_tr_b16 v[120:121], v118 offset:0
  ds_read_b64_tr_b16 v[122:123], v118 offset:8448
  ds_read_b64_tr_b16 v[124:125], v118 offset:128
  ds_read_b64_tr_b16 v[126:127], v118 offset:8576
  ds_read_b64_tr_b16 v[128:129], v118 offset:256
  ds_read_b64_tr_b16 v[130:131], v118 offset:8704
  ds_read_b64_tr_b16 v[132:133], v118 offset:384
  ds_read_b64_tr_b16 v[134:135], v118 offset:8832
  s_waitcnt lgkmcnt(6)
  buffer_store_dwordx4 v[120:123], v1, s[12:15], s70 offen sc1
  s_add_u32 s70, s70, 262144
  s_waitcnt lgkmcnt(4)
  buffer_store_dwordx4 v[124:127], v1, s[12:15], s70 offen sc1
  s_add_u32 s70, s70, 262144
  s_waitcnt lgkmcnt(2)
  buffer_store_dwordx4 v[128:131], v1, s[12:15], s70 offen sc1
  s_add_u32 s70, s70, 262144
  s_waitcnt lgkmcnt(0)
  buffer_store_dwordx4 v[132:135], v1, s[12:15], s70 offen sc1
  v_add_f32_dpp v64, v64, v64 row_shr:1 row_mask:0xf bank_mask:0xf bound_ctrl:0
  v_add_f32_dpp v65, v65, v65 row_shr:1 row_mask:0xf bank_mask:0xf bound_ctrl:0
  s_nop 0
  v_add_f32_dpp v64, v64, v64 row_shr:2 row_mask:0xf bank_mask:0xf bound_ctrl:0
  v_add_f32_dpp v65, v65, v65 row_shr:2 row_mask:0xf bank_mask:0xf bound_ctrl:0
  s_nop 0
  v_add_f32_dpp v64, v64, v64 row_shr:4 row_mask:0xf bank_mask:0xf bound_ctrl:0
  v_add_f32_dpp v65, v65, v65 row_shr:4 row_mask:0xf bank_mask:0xf bound_ctrl:0
  s_nop 0
  v_add_f32_dpp v64, v64, v64 row_shr:8 row_mask:0xf bank_mask:0xf bound_ctrl:0
  v_add_f32_dpp v65, v65, v65 row_shr:8 row_mask:0xf bank_mask:0xf bound_ctrl:0
  s_nop 0
  v_add_f32_dpp v64, v64, v64 row_bcast:15 row_mask:0xa bank_mask:0xf
  v_add_f32_dpp v65, v65, v65 row_bcast:15 row_mask:0xa bank_mask:0xf
  s_nop 0
  v_add_f32_dpp v64, v64, v64 row_bcast:31 row_mask:0xc bank_mask:0xf
  v_add_f32_dpp v65, v65, v65 row_bcast:31 row_mask:0xc bank_mask:0xf
  v_mul_f32 v64, 0x3a800000, v64
  v_mul_f32 v65, 0x3a800000, v65
  v_readlane_b32 s6, v64, 63
  v_readlane_b32 s7, v65, 63
  s_nop 0
  v_subrev_f32 v82, s6, v32
  v_mul_f32 v66, v82, v82
  v_subrev_f32 v83, s7, v48
  v_mul_f32 v74, v83, v83
  v_subrev_f32 v82, s6, v33
  v_mul_f32 v67, v82, v82
  v_subrev_f32 v83, s7, v49
  v_mul_f32 v75, v83, v83
  v_subrev_f32 v82, s6, v34
  v_mul_f32 v68, v82, v82
  v_subrev_f32 v83, s7, v50
  v_mul_f32 v76, v83, v83
  v_subrev_f32 v82, s6, v35
  v_mul_f32 v69, v82, v82
  v_subrev_f32 v83, s7, v51
  v_mul_f32 v77, v83, v83
  v_subrev_f32 v82, s6, v36
  v_fmac_f32 v66, v82, v82
  v_subrev_f32 v83, s7, v52
  v_fmac_f32 v74, v83, v83
  v_subrev_f32 v82, s6, v37
  v_fmac_f32 v67, v82, v82
  v_subrev_f32 v83, s7, v53
  v_fmac_f32 v75, v83, v83
  v_subrev_f32 v82, s6, v38
  v_fmac_f32 v68, v82, v82
  v_subrev_f32 v83, s7, v54
  v_fmac_f32 v76, v83, v83
  v_subrev_f32 v82, s6, v39
  v_fmac_f32 v69, v82, v82
  v_subrev_f32 v83, s7, v55
  v_fmac_f32 v77, v83, v83
  v_subrev_f32 v82, s6, v40
  v_fmac_f32 v66, v82, v82
  v_subrev_f32 v83, s7, v56
  v_fmac_f32 v74, v83, v83
  v_subrev_f32 v82, s6, v41
  v_fmac_f32 v67, v82, v82
  v_subrev_f32 v83, s7, v57
  v_fmac_f32 v75, v83, v83
  v_subrev_f32 v82, s6, v42
  v_fmac_f32 v68, v82, v82
  v_subrev_f32 v83, s7, v58
  v_fmac_f32 v76, v83, v83
  v_subrev_f32 v82, s6, v43
  v_fmac_f32 v69, v82, v82
  v_subrev_f32 v83, s7, v59
  v_fmac_f32 v77, v83, v83
  v_subrev_f32 v82, s6, v44
  v_fmac_f32 v66, v82, v82
  v_subrev_f32 v83, s7, v60
  v_fmac_f32 v74, v83, v83
  v_subrev_f32 v82, s6, v45
  v_fmac_f32 v67, v82, v82
  v_subrev_f32 v83, s7, v61
  v_fmac_f32 v75, v83, v83
  v_subrev_f32 v82, s6, v46
  v_fmac_f32 v68, v82, v82
  v_subrev_f32 v83, s7, v62
  v_fmac_f32 v76, v83, v83
  v_subrev_f32 v82, s6, v47
  v_fmac_f32 v69, v82, v82
  v_subrev_f32 v83, s7, v63
  v_fmac_f32 v77, v83, v83
  v_add_f32 v66, v66, v67
  v_add_f32 v68, v68, v69
  v_add_f32 v74, v74, v75
  v_add_f32 v76, v76, v77
  v_add_f32 v64, v66, v68
  v_add_f32 v65, v74, v76
  s_nop 0
  v_add_f32_dpp v64, v64, v64 row_shr:1 row_mask:0xf bank_mask:0xf bound_ctrl:0
  v_add_f32_dpp v65, v65, v65 row_shr:1 row_mask:0xf bank_mask:0xf bound_ctrl:0
  s_nop 0
  v_add_f32_dpp v64, v64, v64 row_shr:2 row_mask:0xf bank_mask:0xf bound_ctrl:0
  v_add_f32_dpp v65, v65, v65 row_shr:2 row_mask:0xf bank_mask:0xf bound_ctrl:0
  s_nop 0
  v_add_f32_dpp v64, v64, v64 row_shr:4 row_mask:0xf bank_mask:0xf bound_ctrl:0
  v_add_f32_dpp v65, v65, v65 row_shr:4 row_mask:0xf bank_mask:0xf bound_ctrl:0
  s_nop 0
  v_add_f32_dpp v64, v64, v64 row_shr:8 row_mask:0xf bank_mask:0xf bound_ctrl:0
  v_add_f32_dpp v65, v65, v65 row_shr:8 row_mask:0xf bank_mask:0xf bound_ctrl:0
  s_nop 0
  v_add_f32_dpp v64, v64, v64 row_bcast:15 row_mask:0xa bank_mask:0xf
  v_add_f32_dpp v65, v65, v65 row_bcast:15 row_mask:0xa bank_mask:0xf
  s_nop 0
  v_add_f32_dpp v64, v64, v64 row_bcast:31 row_mask:0xc bank_mask:0xf
  v_add_f32_dpp v65, v65, v65 row_bcast:31 row_mask:0xc bank_mask:0xf
  v_mul_f32 v64, 0x3a800000, v64
  v_mul_f32 v65, 0x3a800000, v65
  v_cvt_pk_bf16_f32 v66, v64, v65
  v_lshlrev_b32 v64, 16, v66
  v_and_b32 v65, 0xffff0000, v66
  v_add_f32 v64, 0x3727c5ac, v64
  v_add_f32 v65, 0x3727c5ac, v65
  v_cvt_pk_bf16_f32 v66, v64, v65
  v_lshlrev_b32 v64, 16, v66
  v_and_b32 v65, 0xffff0000, v66
  v_sqrt_f32 v64, v64
  v_sqrt_f32 v65, v65
  s_nop 0
  v_cvt_pk_bf16_f32 v66, v64, v65
  v_lshlrev_b32 v64, 16, v66
  v_and_b32 v65, 0xffff0000, v66
  v_rcp_f32 v64, v64
  v_rcp_f32 v65, v65
  v_mov_b32 v67, s6
  v_mov_b32 v68, s7
  v_cvt_pk_bf16_f32 v66, v67, v68
  v_readlane_b32 s52, v64, 63
  v_readlane_b32 s53, v65, 63
  v_readfirstlane_b32 s54, v66
  s_nop 0
  s_lshl_b32 s6, s54, 16
  s_and_b32 s7, s54, 0xffff0000
  s_waitcnt vmcnt(6)
  v_mov_b32 v64, 0
  v_mov_b32 v65, 0
  v_subrev_f32 v32, s6, v32
  v_subrev_f32 v33, s6, v33
  v_cvt_pk_bf16_f32 v66, v32, v33
  v_lshlrev_b32 v32, 16, v66
  v_and_b32 v33, 0xffff0000, v66
  v_mul_f32 v32, s52, v32
  v_mul_f32 v33, s52, v33
  v_cvt_pk_bf16_f32 v66, v32, v33
  v_dot2_f32_bf16 v64, v66, v20, v64
  v_subrev_f32 v48, s7, v48
  v_subrev_f32 v49, s7, v49
  v_cvt_pk_bf16_f32 v67, v48, v49
  v_lshlrev_b32 v48, 16, v67
  v_and_b32 v49, 0xffff0000, v67
  v_mul_f32 v48, s53, v48
  v_mul_f32 v49, s53, v49
  v_cvt_pk_bf16_f32 v67, v48, v49
  v_dot2_f32_bf16 v65, v67, v20, v65
  v_subrev_f32 v34, s6, v34
  v_subrev_f32 v35, s6, v35
  v_cvt_pk_bf16_f32 v66, v34, v35
  v_lshlrev_b32 v34, 16, v66
  v_and_b32 v35, 0xffff0000, v66
  v_mul_f32 v34, s52, v34
  v_mul_f32 v35, s52, v35
  v_cvt_pk_bf16_f32 v66, v34, v35
  v_dot2_f32_bf16 v64, v66, v21, v64
  v_subrev_f32 v50, s7, v50
  v_subrev_f32 v51, s7, v51
  v_cvt_pk_bf16_f32 v67, v50, v51
  v_lshlrev_b32 v50, 16, v67
  v_and_b32 v51, 0xffff0000, v67
  v_mul_f32 v50, s53, v50
  v_mul_f32 v51, s53, v51
  v_cvt_pk_bf16_f32 v67, v50, v51
  v_dot2_f32_bf16 v65, v67, v21, v65
  v_subrev_f32 v36, s6, v36
  v_subrev_f32 v37, s6, v37
  v_cvt_pk_bf16_f32 v66, v36, v37
  v_lshlrev_b32 v36, 16, v66
  v_and_b32 v37, 0xffff0000, v66
  v_mul_f32 v36, s52, v36
  v_mul_f32 v37, s52, v37
  v_cvt_pk_bf16_f32 v66, v36, v37
  v_dot2_f32_bf16 v64, v66, v22, v64
  v_subrev_f32 v52, s7, v52
  v_subrev_f32 v53, s7, v53
  v_cvt_pk_bf16_f32 v67, v52, v53
  v_lshlrev_b32 v52, 16, v67
  v_and_b32 v53, 0xffff0000, v67
  v_mul_f32 v52, s53, v52
  v_mul_f32 v53, s53, v53
  v_cvt_pk_bf16_f32 v67, v52, v53
  v_dot2_f32_bf16 v65, v67, v22, v65
  v_subrev_f32 v38, s6, v38
  v_subrev_f32 v39, s6, v39
  v_cvt_pk_bf16_f32 v66, v38, v39
  v_lshlrev_b32 v38, 16, v66
  v_and_b32 v39, 0xffff0000, v66
  v_mul_f32 v38, s52, v38
  v_mul_f32 v39, s52, v39
  v_cvt_pk_bf16_f32 v66, v38, v39
  v_dot2_f32_bf16 v64, v66, v23, v64
  v_subrev_f32 v54, s7, v54
  v_subrev_f32 v55, s7, v55
  v_cvt_pk_bf16_f32 v67, v54, v55
  v_lshlrev_b32 v54, 16, v67
  v_and_b32 v55, 0xffff0000, v67
  v_mul_f32 v54, s53, v54
  v_mul_f32 v55, s53, v55
  v_cvt_pk_bf16_f32 v67, v54, v55
  v_dot2_f32_bf16 v65, v67, v23, v65
  v_subrev_f32 v40, s6, v40
  v_subrev_f32 v41, s6, v41
  v_cvt_pk_bf16_f32 v66, v40, v41
  v_lshlrev_b32 v40, 16, v66
  v_and_b32 v41, 0xffff0000, v66
  v_mul_f32 v40, s52, v40
  v_mul_f32 v41, s52, v41
  v_cvt_pk_bf16_f32 v66, v40, v41
  v_dot2_f32_bf16 v64, v66, v24, v64
  v_subrev_f32 v56, s7, v56
  v_subrev_f32 v57, s7, v57
  v_cvt_pk_bf16_f32 v67, v56, v57
  v_lshlrev_b32 v56, 16, v67
  v_and_b32 v57, 0xffff0000, v67
  v_mul_f32 v56, s53, v56
  v_mul_f32 v57, s53, v57
  v_cvt_pk_bf16_f32 v67, v56, v57
  v_dot2_f32_bf16 v65, v67, v24, v65
  v_subrev_f32 v42, s6, v42
  v_subrev_f32 v43, s6, v43
  v_cvt_pk_bf16_f32 v66, v42, v43
  v_lshlrev_b32 v42, 16, v66
  v_and_b32 v43, 0xffff0000, v66
  v_mul_f32 v42, s52, v42
  v_mul_f32 v43, s52, v43
  v_cvt_pk_bf16_f32 v66, v42, v43
  v_dot2_f32_bf16 v64, v66, v25, v64
  v_subrev_f32 v58, s7, v58
  v_subrev_f32 v59, s7, v59
  v_cvt_pk_bf16_f32 v67, v58, v59
  v_lshlrev_b32 v58, 16, v67
  v_and_b32 v59, 0xffff0000, v67
  v_mul_f32 v58, s53, v58
  v_mul_f32 v59, s53, v59
  v_cvt_pk_bf16_f32 v67, v58, v59
  v_dot2_f32_bf16 v65, v67, v25, v65
  v_subrev_f32 v44, s6, v44
  v_subrev_f32 v45, s6, v45
  v_cvt_pk_bf16_f32 v66, v44, v45
  v_lshlrev_b32 v44, 16, v66
  v_and_b32 v45, 0xffff0000, v66
  v_mul_f32 v44, s52, v44
  v_mul_f32 v45, s52, v45
  v_cvt_pk_bf16_f32 v66, v44, v45
  v_dot2_f32_bf16 v64, v66, v26, v64
  v_subrev_f32 v60, s7, v60
  v_subrev_f32 v61, s7, v61
  v_cvt_pk_bf16_f32 v67, v60, v61
  v_lshlrev_b32 v60, 16, v67
  v_and_b32 v61, 0xffff0000, v67
  v_mul_f32 v60, s53, v60
  v_mul_f32 v61, s53, v61
  v_cvt_pk_bf16_f32 v67, v60, v61
  v_dot2_f32_bf16 v65, v67, v26, v65
  v_subrev_f32 v46, s6, v46
  v_subrev_f32 v47, s6, v47
  v_cvt_pk_bf16_f32 v66, v46, v47
  v_lshlrev_b32 v46, 16, v66
  v_and_b32 v47, 0xffff0000, v66
  v_mul_f32 v46, s52, v46
  v_mul_f32 v47, s52, v47
  v_cvt_pk_bf16_f32 v66, v46, v47
  v_dot2_f32_bf16 v64, v66, v27, v64
  v_subrev_f32 v62, s7, v62
  v_subrev_f32 v63, s7, v63
  v_cvt_pk_bf16_f32 v67, v62, v63
  v_lshlrev_b32 v62, 16, v67
  v_and_b32 v63, 0xffff0000, v67
  v_mul_f32 v62, s53, v62
  v_mul_f32 v63, s53, v63
  v_cvt_pk_bf16_f32 v67, v62, v63
  v_dot2_f32_bf16 v65, v67, v27, v65
  v_add_f32_dpp v64, v64, v64 row_shr:1 row_mask:0xf bank_mask:0xf bound_ctrl:0
  s_nop 1
  v_add_f32_dpp v65, v65, v65 row_shr:1 row_mask:0xf bank_mask:0xf bound_ctrl:0
  v_add_f32_dpp v64, v64, v64 row_shr:2 row_mask:0xf bank_mask:0xf bound_ctrl:0
  s_nop 0
  v_add_f32_dpp v65, v65, v65 row_shr:2 row_mask:0xf bank_mask:0xf bound_ctrl:0
  v_add_f32_dpp v64, v64, v64 row_shr:4 row_mask:0xf bank_mask:0xf bound_ctrl:0
  s_nop 0
  v_add_f32_dpp v65, v65, v65 row_shr:4 row_mask:0xf bank_mask:0xf bound_ctrl:0
  v_add_f32_dpp v64, v64, v64 row_shr:8 row_mask:0xf bank_mask:0xf bound_ctrl:0
  s_nop 0
  v_add_f32_dpp v65, v65, v65 row_shr:8 row_mask:0xf bank_mask:0xf bound_ctrl:0
  v_add_f32_dpp v64, v64, v64 row_bcast:15 row_mask:0xa bank_mask:0xf
  s_nop 0
  v_add_f32_dpp v65, v65, v65 row_bcast:15 row_mask:0xa bank_mask:0xf
  v_add_f32_dpp v64, v64, v64 row_bcast:31 row_mask:0xc bank_mask:0xf
  s_nop 0
  v_add_f32_dpp v65, v65, v65 row_bcast:31 row_mask:0xc bank_mask:0xf
  v_cvt_pk_bf16_f32 v66, v64, v65
  s_nop 0
  v_readlane_b32 s54, v66, 63
  s_nop 0
  s_and_b32 s55, s54, 0xffff
  s_lshr_b32 s54, s54, 16
  s_xor_b32 s56, s55, 0xffff
  s_or_b32 s57, s55, 0x8000
  s_cmp_ge_u32 s55, 0x8000
  s_cselect_b32 s55, s56, s57
  s_xor_b32 s56, s54, 0xffff
  s_or_b32 s57, s54, 0x8000
  s_cmp_ge_u32 s54, 0x8000
  s_cselect_b32 s54, s56, s57
  s_lshl_b32 s55, s55, 16
  s_lshl_b32 s54, s54, 16
  s_sub_u32 s56, 2047, s4
  s_or_b32 s55, s55, s56
  s_sub_u32 s56, 2046, s4
  s_or_b32 s54, s54, s56
  s_max_u32 s54, s54, s55
  s_xor_b32 s6, s6, 0x80000000
  s_xor_b32 s7, s7, 0x80000000
  v_mov_b32 v4, s6
  v_mov_b32 v5, s7
  v_mov_b32 v6, s52
  v_mov_b32 v7, s53
  v_mov_b32 v8, s54
  v_mov_b32 v9, 0
  s_lshl_b32 s5, s4, 2
  s_add_u32 s5, s5, 6291456
  s_add_u32 s56, s5, 8192
  s_mov_b64 exec, 1
  ds_max_u32 v116, v8 offset:4
  ds_add_u32 v116, v119
  buffer_store_dwordx2 v[4:5], v9, s[12:15], s5 offen sc1
  buffer_store_dwordx2 v[6:7], v9, s[12:15], s56 offen sc1
  s_mov_b64 exec, -1
  s_cmp_lg_u32 s3, 0
  s_cbranch_scc1 K1_NOKEY
K1_SPINK:
  ds_read_b64 v[10:11], v116
  s_waitcnt lgkmcnt(0)
  v_readfirstlane_b32 s71, v10
  s_nop 1
  s_cmp_lt_u32 s71, 4
  s_cbranch_scc1 K1_SPINK
  s_lshl_b32 s55, s2, 2
  s_add_u32 s55, s55, 6356992
  s_mov_b64 exec, 1
  buffer_store_dword v11, v9, s[12:15], s55 offen sc1
  s_mov_b64 exec, -1
K1_NOKEY:
  s_endpgm
K1_END:
  s_endpgm
.globl k2_kernel
.p2align 8
.type k2_kernel,@function
k2_kernel:
  s_cmp_ge_u32 s2, 256
  s_cbranch_scc1 K2_END
  s_load_dwordx2 s[12:13], s[0:1], 112
  s_load_dwordx2 s[20:21], s[0:1], 72
  s_load_dwordx2 s[24:25], s[0:1], 80
  s_load_dwordx2 s[8:9], s[0:1], 0
  s_load_dwordx2 s[28:29], s[0:1], 88
  s_load_dwordx2 s[32:33], s[0:1], 48
  s_load_dwordx2 s[16:17], s[0:1], 96
  v_lshrrev_b32 v1, 6, v0
  v_and_b32 v2, 63, v0
  v_mov_b32 v4, 0
  v_mov_b32 v5, 0
  v_mov_b32 v6, 0
  v_mov_b32 v7, 0
  v_readfirstlane_b32 s61, v1
  ds_write_b128 v4, v[4:7]
  ds_write_b128 v4, v[4:7] offset:16
  ds_write_b128 v4, v[4:7] offset:32
  ds_write_b128 v4, v[4:7] offset:48
  v_and_b32 v0, 255, v0
  s_mov_b32 s14, 25165824
  s_mov_b32 s15, 0x20000
  s_and_b32 s3, s61, 3
  s_and_b32 s4, s2, 7
  s_lshr_b32 s5, s2, 3
  s_lshl_b32 s6, s4, 5
  s_add_u32 s6, s6, s5
  s_mul_i32 s34, s4, 28
  s_add_u32 s34, s34, s5
  s_cmp_ge_u32 s61, 8
  s_cbranch_scc1 K2_FFNLD
  s_cmp_ge_u32 s61, 4
  s_cbranch_scc1 K2_CONVLD
  v_lshrrev_b32 v148, 2, v2
  v_lshlrev_b32 v148, 7, v148
  v_and_b32 v149, 3, v2
  v_lshl_add_u32 v148, v149, 4, v148
  s_lshr_b32 s7, s6, 1
  s_lshl_b32 s7, s7, 15
  s_and_b32 s39, s6, 1
  s_lshl_b32 s39, s39, 6
  s_add_u32 s7, s7, s39
  s_lshl_b32 s39, s3, 13
  s_add_u32 s7, s7, s39
  s_add_u32 s7, s7, 16777216
  s_add_u32 s39, s7, 4096
  v_lshlrev_b32 v149, 5, v0
  v_lshlrev_b32 v150, 4, v2
  s_mov_b32 s40, 6291456
  s_mov_b32 s41, 6299648
  s_mov_b32 s42, 6356992
  s_waitcnt lgkmcnt(0)
  buffer_load_dwordx4 v[84:87], v148, s[12:15], s7 offen
  buffer_load_dwordx4 v[88:91], v148, s[12:15], s7 offen offset:2048
  buffer_load_dwordx4 v[92:95], v148, s[12:15], s39 offen
  buffer_load_dwordx4 v[96:99], v148, s[12:15], s39 offen offset:2048
  buffer_load_dwordx4 v[20:23], v149, s[12:15], s40 offen
  buffer_load_dwordx4 v[24:27], v149, s[12:15], s40 offen offset:16
  buffer_load_dwordx4 v[28:31], v149, s[12:15], s41 offen
  buffer_load_dwordx4 v[32:35], v149, s[12:15], s41 offen offset:16
  s_lshl_b32 s38, s6, 3
  s_load_dwordx2 s[36:37], s[32:33], s38
  s_lshl_b32 s38, s6, 13
  s_add_u32 s38, s38, 4194304
  s_load_dword s64, s[12:13], s38
  s_add_u32 s38, s38, 2048
  s_load_dword s65, s[12:13], s38
  s_add_u32 s38, s38, 2048
  s_load_dword s66, s[12:13], s38
  s_add_u32 s38, s38, 2048
  s_load_dword s67, s[12:13], s38
  s_barrier
  s_branch K2_AUX
K2_FFNLD:
  s_mov_b32 s22, 7340032
  s_mov_b32 s23, 0x20000
  s_mov_b32 s26, 7340032
  s_mov_b32 s27, 0x20000
  s_lshr_b32 s36, s34, 2
  s_and_b32 s37, s34, 3
  s_lshl_b32 s35, s36, 7
  s_mul_i32 s38, s37, 1835008
  s_add_u32 s35, s35, s38
  s_mul_i32 s38, s3, 458752
  s_add_u32 s35, s35, s38
  v_lshrrev_b32 v117, 3, v2
  v_and_b32 v118, 7, v2
  v_and_b32 v120, 2, v117
  v_xor_b32 v118, v118, v120
  v_mul_u32_u24 v119, 7168, v117
  v_xor_b32 v120, 4, v118
  v_lshl_add_u32 v120, v120, 4, v119
  v_lshl_add_u32 v119, v118, 4, v119
  s_lshl_b32 s46, s3, 14
  s_add_u32 s46, s46, 73728
  s_waitcnt lgkmcnt(0)
  v_lshlrev_b32 v121, 4, v2
  s_mov_b32 s42, 6356992
  buffer_load_dwordx4 v[112:115], v121, s[12:15], s42 offen
  v_mov_b32 v124, 0
  v_mov_b32 v125, 1
  s_barrier
  s_branch K2_FFN
K2_CONVLD:
  s_setprio 1
  s_lshl_b32 s35, s6, 2
  s_add_u32 s35, s35, s3
  s_lshl_b32 s35, s35, 11
  s_add_u32 s35, s35, 4194304
  v_lshlrev_b32 v142, 4, v2
  v_mov_b32 v155, 0
  s_getpc_b64 s[44:45]
K2_PC:
  s_add_u32 s44, s44, K2_CONST-K2_PC
  s_addc_u32 s45, s45, 0
  v_add_u32 v146, 4096, v142
  s_waitcnt lgkmcnt(0)
  buffer_load_dwordx4 v[72:75], v142, s[12:15], s35 offen offset:16
  buffer_load_dwordx4 v[76:79], v142, s[12:15], s35 offen offset:12
  buffer_load_dword v108, v142, s[12:15], s35 offen offset:8
  buffer_load_dwordx4 v[88:91], v142, s[12:15], s35 offen offset:1040
  buffer_load_dwordx4 v[92:95], v142, s[12:15], s35 offen offset:1036
  buffer_load_dword v109, v142, s[12:15], s35 offen offset:1032
  buffer_load_ushort v154, v155, s[12:15], s35 offen offset:1550
  s_barrier
  global_load_dwordx4 v[48:51], v142, s[44:45]
  global_load_dwordx4 v[12:15], v142, s[44:45] offset:1024
  global_load_dwordx4 v[44:47], v142, s[44:45] offset:2048
  global_load_dwordx4 v[8:11], v142, s[44:45] offset:3072
  global_load_dwordx4 v[24:27], v146, s[44:45]
  global_load_dwordx4 v[56:59], v146, s[44:45] offset:1024
  global_load_dwordx4 v[128:131], v146, s[44:45] offset:2048
  v_mov_b32 v104, 0
  v_mov_b32 v105, 0
  v_mov_b32 v106, 0
  v_mov_b32 v107, 0
  s_mul_i32 s38, s3, 17152
  s_add_u32 s38, s38, 5120
  v_mov_b32 v156, 1
  v_and_b32 v152, 15, v2
  v_lshrrev_b32 v153, 4, v2
  v_add_u32 v145, s38, v142
  s_mov_b32 s40, -1
  s_mov_b32 s41, 0
  s_mov_b64 exec, s[40:41]
  ds_write_b128 v145, v[104:107]
  s_mov_b64 exec, -1
  v_lshlrev_b32 v141, 5, v152
  v_add_u32 v141, s38, v141
  v_lshl_add_u32 v159, v153, 4, v141
  v_lshl_add_u32 v160, v153, 3, v141
  v_lshrrev_b32 v142, 2, v152
  v_and_b32 v143, 3, v152
  v_mul_u32_u24 v140, 2112, v142
  v_lshl_add_u32 v140, v143, 3, v140
  v_add_u32 v140, s38, v140
  v_add_u32 v140, 4608, v140
  v_lshlrev_b32 v146, 4, v153
  v_sub_u32 v158, v140, v146
  v_lshlrev_b32 v146, 3, v153
  v_sub_u32 v157, v140, v146
  s_waitcnt vmcnt(7)
  v_alignbit_b32 v96, v88, v92, 16
  v_alignbit_b32 v97, v89, v88, 16
  v_alignbit_b32 v98, v90, v89, 16
  v_alignbit_b32 v99, v91, v90, 16
  v_alignbit_b32 v100, v92, v109, 16
  v_alignbit_b32 v101, v88, v92, 16
  v_alignbit_b32 v102, v89, v88, 16
  v_alignbit_b32 v103, v90, v89, 16
  v_alignbit_b32 v80, v72, v76, 16
  v_alignbit_b32 v81, v73, v72, 16
  v_alignbit_b32 v82, v74, v73, 16
  v_alignbit_b32 v83, v75, v74, 16
  v_alignbit_b32 v84, v76, v108, 16
  v_alignbit_b32 v85, v72, v76, 16
  v_alignbit_b32 v86, v73, v72, 16
  v_alignbit_b32 v87, v74, v73, 16
  s_mov_b32 s40, -1
  s_mov_b32 s41, 0xffffff
  s_mov_b64 exec, s[40:41]
  ds_write_b128 v145, v[88:91] offset:5632
  ds_write_b128 v145, v[96:99] offset:7744
  ds_write_b128 v145, v[92:95] offset:9856
  ds_write_b128 v145, v[100:103] offset:11968
  s_mov_b64 exec, -1
  ds_read_b64_tr_b16 v[32:33], v157 offset:1584
  ds_read_b64_tr_b16 v[34:35], v157 offset:1760
  ds_read_b64_tr_b16 v[64:65], v157 offset:1616
  ds_read_b64_tr_b16 v[66:67], v157 offset:1792
  ds_read_b64_tr_b16 v[28:29], v157 offset:1648
  ds_read_b64_tr_b16 v[30:31], v157 offset:1824
  ds_read_b64_tr_b16 v[60:61], v157 offset:1680
  ds_read_b64_tr_b16 v[62:63], v157 offset:1856
  ds_read_b64_tr_b16 v[68:69], v157 offset:1136
  ds_read_b64_tr_b16 v[70:71], v157 offset:1248
  ds_read_b64_tr_b16 v[36:37], v157 offset:1360
  ds_read_b64_tr_b16 v[38:39], v157 offset:1472
  ds_read_b64_tr_b16 v[4:5], v157 offset:1168
  ds_read_b64_tr_b16 v[6:7], v157 offset:1280
  ds_read_b64_tr_b16 v[40:41], v157 offset:1392
  ds_read_b64_tr_b16 v[42:43], v157 offset:1504
  ds_read_b64_tr_b16 v[52:53], v157 offset:1200
  ds_read_b64_tr_b16 v[54:55], v157 offset:1312
  ds_read_b64_tr_b16 v[16:17], v157 offset:1424
  ds_read_b64_tr_b16 v[18:19], v157 offset:1536
  ds_write_b128 v145, v[72:75] offset:4608
  ds_write_b128 v145, v[80:83] offset:6720
  ds_write_b128 v145, v[76:79] offset:8832
  ds_write_b128 v145, v[84:87] offset:10944
  s_waitcnt vmcnt(0)
  v_mul_u32_u24 v128, v154, v128
  v_mul_u32_u24 v129, v154, v129
  v_mul_u32_u24 v130, v154, v130
  v_mul_u32_u24 v131, v154, v131
K2_SPINU:
  ds_read_b32 v148, v155 offset:12
  s_waitcnt lgkmcnt(0)
  v_readfirstlane_b32 s44, v148
  s_nop 1
  s_cmp_lt_u32 s44, 4
  s_cbranch_scc1 K2_SPINU
  s_setprio 2
  ds_read_b128 v[104:107], v159 offset:480
  ds_read_b128 v[108:111], v159 offset:464
  ds_read_b128 v[112:115], v159 offset:992
  ds_read_b128 v[116:119], v159 offset:976
  s_waitcnt lgkmcnt(2)
  v_mfma_f32_16x16x32_f16 v[132:135], v[104:107], v[48:51], 0
  v_mfma_f32_16x16x32_f16 v[136:139], v[104:107], v[12:15], 0
  v_mfma_f32_16x16x32_f16 v[140:143], v[104:107], v[44:47], 0
  v_mfma_f32_16x16x32_f16 v[144:147], v[108:111], v[8:11], 0
  v_mfma_f32_16x16x32_f16 v[120:123], v[104:107], v[24:27], 0
  v_mfma_f32_16x16x32_f16 v[124:127], v[108:111], v[56:59], 0
  s_waitcnt lgkmcnt(0)
  s_nop 1
  v_cvt_pk_f16_f32 v72, v132, v133
  v_cvt_pk_f16_f32 v73, v134, v135
  v_cvt_pk_f16_f32 v74, v136, v137
  v_cvt_pk_f16_f32 v75, v138, v139
  v_cvt_pk_f16_f32 v76, v140, v141
  v_cvt_pk_f16_f32 v77, v142, v143
  v_cvt_pk_f16_f32 v78, v144, v145
  v_cvt_pk_f16_f32 v79, v146, v147
  v_mfma_f32_16x16x32_f16 v[132:135], v[112:115], v[48:51], 0
  v_cvt_pk_f16_f32 v20, v120, v121
  v_mfma_f32_16x16x32_f16 v[136:139], v[112:115], v[12:15], 0
  v_cvt_pk_f16_f32 v21, v122, v123
  v_mfma_f32_16x16x32_f16 v[140:143], v[112:115], v[44:47], 0
  v_cvt_pk_f16_f32 v22, v124, v125
  v_mfma_f32_16x16x32_f16 v[144:147], v[116:119], v[8:11], 0
  v_cvt_pk_f16_f32 v23, v126, v127
  v_mfma_f32_16x16x32_f16 v[120:123], v[112:115], v[24:27], 0
  v_mfma_f32_16x16x32_f16 v[124:127], v[116:119], v[56:59], 0
  ds_read_b128 v[104:107], v159 offset:1504
  ds_read_b128 v[108:111], v159 offset:1488
  v_mfma_f32_16x16x32_f16 v[80:83], v[72:75], v[68:71], 0
  v_mfma_f32_16x16x32_f16 v[84:87], v[72:75], v[4:7], 0
  v_mfma_f32_16x16x32_f16 v[88:91], v[72:75], v[52:55], 0
  v_mfma_f32_16x16x32_f16 v[80:83], v[76:79], v[36:39], v[80:83]
  v_cvt_pk_f16_f32 v72, v132, v133
  v_cvt_pk_f16_f32 v73, v134, v135
  v_mfma_f32_16x16x32_f16 v[84:87], v[76:79], v[40:43], v[84:87]
  v_cvt_pk_f16_f32 v74, v136, v137
  v_mfma_f32_16x16x32_f16 v[88:91], v[76:79], v[16:19], v[88:91]
  v_cvt_pk_f16_f32 v75, v138, v139
  v_mfma_f32_16x16x32_f16 v[88:91], v[20:23], v[32:35], v[88:91]
  v_cvt_pk_f16_f32 v76, v140, v141
  v_mfma_f32_16x16x32_f16 v[92:95], v[20:23], v[64:67], 0
  v_cvt_pk_f16_f32 v77, v142, v143
  v_mfma_f32_16x16x32_f16 v[96:99], v[20:23], v[28:31], 0
  v_cvt_pk_f16_f32 v78, v144, v145
  v_mfma_f32_16x16x32_f16 v[100:103], v[20:23], v[60:63], 0
  v_cvt_pk_f16_f32 v79, v146, v147
  s_waitcnt lgkmcnt(0)
  v_mfma_f32_16x16x32_f16 v[132:135], v[104:107], v[48:51], 0
  v_cvt_pk_f16_f32 v20, v120, v121
  v_mfma_f32_16x16x32_f16 v[136:139], v[104:107], v[12:15], 0
  v_cvt_pk_f16_f32 v21, v122, v123
  v_mfma_f32_16x16x32_f16 v[140:143], v[104:107], v[44:47], 0
  v_cvt_pk_f16_f32 v22, v124, v125
  v_mfma_f32_16x16x32_f16 v[144:147], v[108:111], v[8:11], 0
  v_cvt_pk_f16_f32 v23, v126, v127
  v_mfma_f32_16x16x32_f16 v[120:123], v[104:107], v[24:27], 0
  v_mfma_f32_16x16x32_f16 v[124:127], v[108:111], v[56:59], 0
  ds_read_b128 v[112:115], v159 offset:2016
  ds_read_b128 v[116:119], v159 offset:2000
  v_mfma_f32_16x16x32_f16 v[84:87], v[72:75], v[68:71], v[84:87]
  v_mfma_f32_16x16x32_f16 v[88:91], v[72:75], v[4:7], v[88:91]
  v_mfma_f32_16x16x32_f16 v[92:95], v[72:75], v[52:55], v[92:95]
  v_mfma_f32_16x16x32_f16 v[84:87], v[76:79], v[36:39], v[84:87]
  v_cvt_pk_f16_f32 v72, v132, v133
  v_cvt_pk_f16_f32 v73, v134, v135
  v_mfma_f32_16x16x32_f16 v[88:91], v[76:79], v[40:43], v[88:91]
  v_cvt_pk_f16_f32 v74, v136, v137
  v_mfma_f32_16x16x32_f16 v[92:95], v[76:79], v[16:19], v[92:95]
  v_cvt_pk_f16_f32 v75, v138, v139
  v_mfma_f32_16x16x32_f16 v[92:95], v[20:23], v[32:35], v[92:95]
  v_cvt_pk_f16_f32 v76, v140, v141
  v_cvt_pk_f16_f32 v77, v142, v143
  v_mfma_f32_16x16x32_f16 v[96:99], v[20:23], v[64:67], v[96:99]
  v_cvt_pk_f16_f32 v78, v144, v145
  v_mfma_f32_16x16x32_f16 v[100:103], v[20:23], v[28:31], v[100:103]
  v_cvt_pk_f16_f32 v79, v146, v147
  s_waitcnt lgkmcnt(0)
  v_mfma_f32_16x16x32_f16 v[132:135], v[112:115], v[48:51], 0
  v_cvt_pk_f16_f32 v20, v120, v121
  v_mfma_f32_16x16x32_f16 v[136:139], v[112:115], v[12:15], 0
  v_cvt_pk_f16_f32 v21, v122, v123
  v_mfma_f32_16x16x32_f16 v[140:143], v[112:115], v[44:47], 0
  v_cvt_pk_f16_f32 v22, v124, v125
  v_mfma_f32_16x16x32_f16 v[144:147], v[116:119], v[8:11], 0
  v_cvt_pk_f16_f32 v23, v126, v127
  v_mfma_f32_16x16x32_f16 v[120:123], v[112:115], v[24:27], 0
  v_mfma_f32_16x16x32_f16 v[124:127], v[116:119], v[56:59], 0
  ds_read_b128 v[104:107], v159 offset:2528
  ds_read_b128 v[108:111], v159 offset:2512
  v_mfma_f32_16x16x32_f16 v[88:91], v[72:75], v[68:71], v[88:91]
  v_mfma_f32_16x16x32_f16 v[92:95], v[72:75], v[4:7], v[92:95]
  v_mfma_f32_16x16x32_f16 v[96:99], v[72:75], v[52:55], v[96:99]
  v_mfma_f32_16x16x32_f16 v[88:91], v[76:79], v[36:39], v[88:91]
  v_cvt_pk_f16_f32 v72, v132, v133
  v_cvt_pk_f16_f32 v73, v134, v135
  v_mfma_f32_16x16x32_f16 v[92:95], v[76:79], v[40:43], v[92:95]
  v_cvt_pk_f16_f32 v74, v136, v137
  v_mfma_f32_16x16x32_f16 v[96:99], v[76:79], v[16:19], v[96:99]
  v_cvt_pk_f16_f32 v75, v138, v139
  v_mfma_f32_16x16x32_f16 v[96:99], v[20:23], v[32:35], v[96:99]
  v_cvt_pk_f16_f32 v76, v140, v141
  v_cvt_pk_f16_f32 v77, v142, v143
  v_mfma_f32_16x16x32_f16 v[100:103], v[20:23], v[64:67], v[100:103]
  v_cvt_pk_f16_f32 v78, v144, v145
  v_cvt_pk_f16_f32 v79, v146, v147
  s_waitcnt lgkmcnt(0)
  v_mfma_f32_16x16x32_f16 v[132:135], v[104:107], v[48:51], 0
  v_cvt_pk_f16_f32 v20, v120, v121
  v_mfma_f32_16x16x32_f16 v[136:139], v[104:107], v[12:15], 0
  v_cvt_pk_f16_f32 v21, v122, v123
  v_mfma_f32_16x16x32_f16 v[140:143], v[104:107], v[44:47], 0
  v_cvt_pk_f16_f32 v22, v124, v125
  v_mfma_f32_16x16x32_f16 v[144:147], v[108:111], v[8:11], 0
  v_cvt_pk_f16_f32 v23, v126, v127
  ds_read_b128 v[112:115], v159 offset:3040
  ds_read_b128 v[116:119], v159 offset:3024
  ds_read_b64_tr_b16 v[24:25], v158 offset:400
  ds_read_b64_tr_b16 v[26:27], v158 offset:392
  ds_read_b64_tr_b16 v[56:57], v158 offset:912
  ds_read_b64_tr_b16 v[58:59], v158 offset:904
  v_mfma_f32_16x16x32_f16 v[92:95], v[72:75], v[68:71], v[92:95]
  v_mfma_f32_16x16x32_f16 v[96:99], v[72:75], v[4:7], v[96:99]
  v_mfma_f32_16x16x32_f16 v[100:103], v[72:75], v[52:55], v[100:103]
  v_mfma_f32_16x16x32_f16 v[92:95], v[76:79], v[36:39], v[92:95]
  v_cvt_pk_f16_f32 v72, v132, v133
  v_cvt_pk_f16_f32 v73, v134, v135
  v_mfma_f32_16x16x32_f16 v[96:99], v[76:79], v[40:43], v[96:99]
  v_cvt_pk_f16_f32 v74, v136, v137
  v_mfma_f32_16x16x32_f16 v[100:103], v[76:79], v[16:19], v[100:103]
  v_cvt_pk_f16_f32 v75, v138, v139
  v_mfma_f32_16x16x32_f16 v[100:103], v[20:23], v[32:35], v[100:103]
  v_cvt_pk_f16_f32 v76, v140, v141
  v_cvt_pk_f16_f32 v77, v142, v143
  v_cvt_pk_f16_f32 v78, v144, v145
  v_cvt_pk_f16_f32 v79, v146, v147
  s_waitcnt lgkmcnt(4)
  v_mfma_f32_16x16x32_f16 v[132:135], v[112:115], v[48:51], 0
  v_mfma_f32_16x16x32_f16 v[136:139], v[112:115], v[12:15], 0
  v_mfma_f32_16x16x32_f16 v[140:143], v[112:115], v[44:47], 0
  v_mfma_f32_16x16x32_f16 v[144:147], v[116:119], v[8:11], 0
  ds_read_b64_tr_b16 v[32:33], v158 offset:528
  ds_read_b64_tr_b16 v[34:35], v158 offset:520
  ds_read_b64_tr_b16 v[64:65], v158 offset:1040
  ds_read_b64_tr_b16 v[66:67], v158 offset:1032
  ds_read_b64_tr_b16 v[28:29], v158 offset:464
  ds_read_b64_tr_b16 v[30:31], v158 offset:456
  ds_read_b64_tr_b16 v[60:61], v158 offset:976
  ds_read_b64_tr_b16 v[62:63], v158 offset:968
  ds_read_b64_tr_b16 v[20:21], v158 offset:336
  ds_read_b64_tr_b16 v[22:23], v158 offset:328
  ds_read_b64_tr_b16 v[52:53], v158 offset:848
  ds_read_b64_tr_b16 v[54:55], v158 offset:840
  ds_read_b64_tr_b16 v[16:17], v158 offset:272
  ds_read_b64_tr_b16 v[18:19], v158 offset:264
  ds_read_b64_tr_b16 v[48:49], v158 offset:784
  ds_read_b64_tr_b16 v[50:51], v158 offset:776
  ds_read_b64_tr_b16 v[12:13], v158 offset:208
  ds_read_b64_tr_b16 v[14:15], v158 offset:200
  ds_read_b64_tr_b16 v[44:45], v158 offset:720
  ds_read_b64_tr_b16 v[46:47], v158 offset:712
  ds_read_b64_tr_b16 v[8:9], v158 offset:144
  ds_read_b64_tr_b16 v[10:11], v158 offset:136
  v_mfma_f32_16x16x32_f16 v[96:99], v[72:75], v[68:71], v[96:99]
  v_mfma_f32_16x16x32_f16 v[100:103], v[72:75], v[4:7], v[100:103]
  v_mfma_f32_16x16x32_f16 v[96:99], v[76:79], v[36:39], v[96:99]
  v_cvt_pk_f16_f32 v72, v132, v133
  v_cvt_pk_f16_f32 v73, v134, v135
  v_mfma_f32_16x16x32_f16 v[100:103], v[76:79], v[40:43], v[100:103]
  v_cvt_pk_f16_f32 v74, v136, v137
  v_cvt_pk_f16_f32 v75, v138, v139
  v_cvt_pk_f16_f32 v76, v140, v141
  v_cvt_pk_f16_f32 v77, v142, v143
  v_cvt_pk_f16_f32 v78, v144, v145
  v_cvt_pk_f16_f32 v79, v146, v147
  ds_read_b64_tr_b16 v[4:5], v158 offset:80
  ds_read_b64_tr_b16 v[6:7], v158 offset:72
  ds_read_b64_tr_b16 v[40:41], v158 offset:656
  ds_read_b64_tr_b16 v[42:43], v158 offset:648
  v_mfma_f32_16x16x32_f16 v[100:103], v[72:75], v[68:71], v[100:103]
  v_mfma_f32_16x16x32_f16 v[100:103], v[76:79], v[36:39], v[100:103]
  ds_read_b64_tr_b16 v[36:37], v158 offset:592
  ds_read_b64_tr_b16 v[38:39], v158 offset:584
  ds_read_b64_tr_b16 v[68:69], v158 offset:1104
  ds_read_b64_tr_b16 v[70:71], v158 offset:1096
  ds_read_b128 v[104:107], v159 offset:32
  ds_read_b128 v[108:111], v159 offset:96
  ds_read_b128 v[112:115], v159 offset:160
  ds_read_b128 v[116:119], v159 offset:224
  ds_read_b128 v[120:123], v159 offset:288
  ds_read_b128 v[124:127], v159 offset:352
  s_waitcnt lgkmcnt(5)
  v_mfma_f32_16x16x32_f16 v[72:75], v[32:35], v[104:107], 0
  v_mfma_f32_16x16x32_f16 v[76:79], v[64:67], v[104:107], 0
  ds_read_b128 v[104:107], v159 offset:416
  s_waitcnt lgkmcnt(5)
  v_mfma_f32_16x16x32_f16 v[72:75], v[28:31], v[108:111], v[72:75]
  v_mfma_f32_16x16x32_f16 v[76:79], v[60:63], v[108:111], v[76:79]
  ds_read_b128 v[108:111], v159 offset:480
  s_waitcnt lgkmcnt(5)
  v_mfma_f32_16x16x32_f16 v[72:75], v[24:27], v[112:115], v[72:75]
  v_mfma_f32_16x16x32_f16 v[76:79], v[56:59], v[112:115], v[76:79]
  ds_read_b128 v[112:115], v159 offset:544
  s_waitcnt lgkmcnt(5)
  v_mfma_f32_16x16x32_f16 v[72:75], v[20:23], v[116:119], v[72:75]
  v_mfma_f32_16x16x32_f16 v[76:79], v[52:55], v[116:119], v[76:79]
  ds_read_b128 v[116:119], v159 offset:608
  s_waitcnt lgkmcnt(5)
  v_mfma_f32_16x16x32_f16 v[72:75], v[16:19], v[120:123], v[72:75]
  v_mfma_f32_16x16x32_f16 v[76:79], v[48:51], v[120:123], v[76:79]
  ds_read_b128 v[120:123], v159 offset:672
  s_waitcnt lgkmcnt(5)
  v_mfma_f32_16x16x32_f16 v[72:75], v[12:15], v[124:127], v[72:75]
  v_mfma_f32_16x16x32_f16 v[76:79], v[44:47], v[124:127], v[76:79]
  ds_read_b128 v[124:127], v159 offset:736
  s_waitcnt lgkmcnt(5)
  v_mfma_f32_16x16x32_f16 v[72:75], v[8:11], v[104:107], v[72:75]
  v_mfma_f32_16x16x32_f16 v[76:79], v[40:43], v[104:107], v[76:79]
  ds_read_b128 v[104:107], v159 offset:800
  s_waitcnt lgkmcnt(5)
  v_mfma_f32_16x16x32_f16 v[72:75], v[4:7], v[108:111], v[72:75]
  v_mfma_f32_16x16x32_f16 v[76:79], v[36:39], v[108:111], v[76:79]
  v_mfma_f32_16x16x32_f16 v[80:83], v[68:71], v[108:111], v[80:83]
  v_mfma_f32_16x16x32_f16 v[88:91], v[128:131], v[108:111], v[88:91]
  ds_read_b128 v[108:111], v159 offset:864
  s_waitcnt lgkmcnt(5)
  v_mfma_f32_16x16x32_f16 v[76:79], v[32:35], v[112:115], v[76:79]
  v_mfma_f32_16x16x32_f16 v[80:83], v[64:67], v[112:115], v[80:83]
  ds_read_b128 v[112:115], v159 offset:928
  s_waitcnt lgkmcnt(5)
  v_mfma_f32_16x16x32_f16 v[76:79], v[28:31], v[116:119], v[76:79]
  v_mfma_f32_16x16x32_f16 v[80:83], v[60:63], v[116:119], v[80:83]
  v_cvt_pk_bf16_f32 v148, v72, v73
  v_cvt_pk_bf16_f32 v149, v74, v75
  ds_write_b64 v160, v[148:149] offset:4608
  ds_read_b128 v[116:119], v159 offset:992
  s_waitcnt lgkmcnt(6)
  v_mfma_f32_16x16x32_f16 v[76:79], v[24:27], v[120:123], v[76:79]
  v_mfma_f32_16x16x32_f16 v[80:83], v[56:59], v[120:123], v[80:83]
  ds_read_b128 v[120:123], v159 offset:1056
  s_waitcnt lgkmcnt(6)
  v_mfma_f32_16x16x32_f16 v[76:79], v[20:23], v[124:127], v[76:79]
  v_mfma_f32_16x16x32_f16 v[80:83], v[52:55], v[124:127], v[80:83]
  ds_read_b128 v[124:127], v159 offset:1120
  s_waitcnt lgkmcnt(6)
  v_mfma_f32_16x16x32_f16 v[76:79], v[16:19], v[104:107], v[76:79]
  v_mfma_f32_16x16x32_f16 v[80:83], v[48:51], v[104:107], v[80:83]
  ds_read_b128 v[104:107], v159 offset:1184
  s_waitcnt lgkmcnt(6)
  v_mfma_f32_16x16x32_f16 v[76:79], v[12:15], v[108:111], v[76:79]
  v_mfma_f32_16x16x32_f16 v[80:83], v[44:47], v[108:111], v[80:83]
  ds_read_b128 v[108:111], v159 offset:1248
  s_waitcnt lgkmcnt(6)
  v_mfma_f32_16x16x32_f16 v[76:79], v[8:11], v[112:115], v[76:79]
  v_mfma_f32_16x16x32_f16 v[80:83], v[40:43], v[112:115], v[80:83]
  ds_read_b128 v[112:115], v159 offset:1312
  s_waitcnt lgkmcnt(5)
  v_mfma_f32_16x16x32_f16 v[76:79], v[4:7], v[116:119], v[76:79]
  v_mfma_f32_16x16x32_f16 v[80:83], v[36:39], v[116:119], v[80:83]
  v_mfma_f32_16x16x32_f16 v[84:87], v[68:71], v[116:119], v[84:87]
  v_mfma_f32_16x16x32_f16 v[92:95], v[128:131], v[116:119], v[92:95]
  ds_read_b128 v[116:119], v159 offset:1376
  s_waitcnt lgkmcnt(5)
  v_mfma_f32_16x16x32_f16 v[80:83], v[32:35], v[120:123], v[80:83]
  v_mfma_f32_16x16x32_f16 v[84:87], v[64:67], v[120:123], v[84:87]
  ds_read_b128 v[120:123], v159 offset:1440
  s_waitcnt lgkmcnt(5)
  v_mfma_f32_16x16x32_f16 v[80:83], v[28:31], v[124:127], v[80:83]
  v_mfma_f32_16x16x32_f16 v[84:87], v[60:63], v[124:127], v[84:87]
  v_cvt_pk_bf16_f32 v150, v76, v77
  v_cvt_pk_bf16_f32 v151, v78, v79
  ds_write_b64 v160, v[150:151] offset:5120
  s_mov_b64 exec, 1
  ds_add_u32 v155, v156 offset:32
  s_mov_b64 exec, -1
  ds_read_b128 v[124:127], v159 offset:1504
  s_waitcnt lgkmcnt(7)
  v_mfma_f32_16x16x32_f16 v[80:83], v[24:27], v[104:107], v[80:83]
  v_mfma_f32_16x16x32_f16 v[84:87], v[56:59], v[104:107], v[84:87]
  ds_read_b128 v[104:107], v159 offset:1568
  s_waitcnt lgkmcnt(7)
  v_mfma_f32_16x16x32_f16 v[80:83], v[20:23], v[108:111], v[80:83]
  v_mfma_f32_16x16x32_f16 v[84:87], v[52:55], v[108:111], v[84:87]
  ds_read_b128 v[108:111], v159 offset:1632
  s_waitcnt lgkmcnt(7)
  v_mfma_f32_16x16x32_f16 v[80:83], v[16:19], v[112:115], v[80:83]
  v_mfma_f32_16x16x32_f16 v[84:87], v[48:51], v[112:115], v[84:87]
  ds_read_b128 v[112:115], v159 offset:1696
  s_waitcnt lgkmcnt(7)
  v_mfma_f32_16x16x32_f16 v[80:83], v[12:15], v[116:119], v[80:83]
  v_mfma_f32_16x16x32_f16 v[84:87], v[44:47], v[116:119], v[84:87]
  ds_read_b128 v[116:119], v159 offset:1760
  s_waitcnt lgkmcnt(7)
  v_mfma_f32_16x16x32_f16 v[80:83], v[8:11], v[120:123], v[80:83]
  v_mfma_f32_16x16x32_f16 v[84:87], v[40:43], v[120:123], v[84:87]
  ds_read_b128 v[120:123], v159 offset:1824
  s_waitcnt lgkmcnt(5)
  v_mfma_f32_16x16x32_f16 v[80:83], v[4:7], v[124:127], v[80:83]
  v_mfma_f32_16x16x32_f16 v[84:87], v[36:39], v[124:127], v[84:87]
  v_mfma_f32_16x16x32_f16 v[88:91], v[68:71], v[124:127], v[88:91]
  v_mfma_f32_16x16x32_f16 v[96:99], v[128:131], v[124:127], v[96:99]
  ds_read_b128 v[124:127], v159 offset:1888
  s_waitcnt lgkmcnt(5)
  v_mfma_f32_16x16x32_f16 v[84:87], v[32:35], v[104:107], v[84:87]
  v_mfma_f32_16x16x32_f16 v[88:91], v[64:67], v[104:107], v[88:91]
  ds_read_b128 v[104:107], v159 offset:1952
  s_waitcnt lgkmcnt(5)
  v_mfma_f32_16x16x32_f16 v[84:87], v[28:31], v[108:111], v[84:87]
  v_mfma_f32_16x16x32_f16 v[88:91], v[60:63], v[108:111], v[88:91]
  v_cvt_pk_bf16_f32 v148, v80, v81
  v_cvt_pk_bf16_f32 v149, v82, v83
  ds_write_b64 v160, v[148:149] offset:5632
  ds_read_b128 v[108:111], v159 offset:2016
  s_waitcnt lgkmcnt(6)
  v_mfma_f32_16x16x32_f16 v[84:87], v[24:27], v[112:115], v[84:87]
  v_mfma_f32_16x16x32_f16 v[88:91], v[56:59], v[112:115], v[88:91]
  ds_read_b128 v[112:115], v159 offset:2080
  s_waitcnt lgkmcnt(6)
  v_mfma_f32_16x16x32_f16 v[84:87], v[20:23], v[116:119], v[84:87]
  v_mfma_f32_16x16x32_f16 v[88:91], v[52:55], v[116:119], v[88:91]
  ds_read_b128 v[116:119], v159 offset:2144
  s_waitcnt lgkmcnt(6)
  v_mfma_f32_16x16x32_f16 v[84:87], v[16:19], v[120:123], v[84:87]
  v_mfma_f32_16x16x32_f16 v[88:91], v[48:51], v[120:123], v[88:91]
  ds_read_b128 v[120:123], v159 offset:2208
  s_waitcnt lgkmcnt(6)
  v_mfma_f32_16x16x32_f16 v[84:87], v[12:15], v[124:127], v[84:87]
  v_mfma_f32_16x16x32_f16 v[88:91], v[44:47], v[124:127], v[88:91]
  ds_read_b128 v[124:127], v159 offset:2272
  s_waitcnt lgkmcnt(6)
  v_mfma_f32_16x16x32_f16 v[84:87], v[8:11], v[104:107], v[84:87]
  v_mfma_f32_16x16x32_f16 v[88:91], v[40:43], v[104:107], v[88:91]
  ds_read_b128 v[104:107], v159 offset:2336
  s_waitcnt lgkmcnt(5)
  v_mfma_f32_16x16x32_f16 v[84:87], v[4:7], v[108:111], v[84:87]
  v_mfma_f32_16x16x32_f16 v[88:91], v[36:39], v[108:111], v[88:91]
  v_mfma_f32_16x16x32_f16 v[92:95], v[68:71], v[108:111], v[92:95]
  v_mfma_f32_16x16x32_f16 v[100:103], v[128:131], v[108:111], v[100:103]
  ds_read_b128 v[108:111], v159 offset:2400
  s_waitcnt lgkmcnt(5)
  v_mfma_f32_16x16x32_f16 v[88:91], v[32:35], v[112:115], v[88:91]
  v_mfma_f32_16x16x32_f16 v[92:95], v[64:67], v[112:115], v[92:95]
  ds_read_b128 v[112:115], v159 offset:2464
  s_waitcnt lgkmcnt(5)
  v_mfma_f32_16x16x32_f16 v[88:91], v[28:31], v[116:119], v[88:91]
  v_mfma_f32_16x16x32_f16 v[92:95], v[60:63], v[116:119], v[92:95]
  v_cvt_pk_bf16_f32 v150, v84, v85
  v_cvt_pk_bf16_f32 v151, v86, v87
  ds_write_b64 v160, v[150:151] offset:6144
  s_mov_b64 exec, 1
  ds_add_u32 v155, v156 offset:36
  s_mov_b64 exec, -1
  ds_read_b128 v[116:119], v159 offset:2528
  s_waitcnt lgkmcnt(7)
  v_mfma_f32_16x16x32_f16 v[88:91], v[24:27], v[120:123], v[88:91]
  v_mfma_f32_16x16x32_f16 v[92:95], v[56:59], v[120:123], v[92:95]
  ds_read_b128 v[120:123], v159 offset:2592
  s_waitcnt lgkmcnt(7)
  v_mfma_f32_16x16x32_f16 v[88:91], v[20:23], v[124:127], v[88:91]
  v_mfma_f32_16x16x32_f16 v[92:95], v[52:55], v[124:127], v[92:95]
  ds_read_b128 v[124:127], v159 offset:2656
  s_waitcnt lgkmcnt(7)
  v_mfma_f32_16x16x32_f16 v[88:91], v[16:19], v[104:107], v[88:91]
  v_mfma_f32_16x16x32_f16 v[92:95], v[48:51], v[104:107], v[92:95]
  ds_read_b128 v[104:107], v159 offset:2720
  s_waitcnt lgkmcnt(7)
  v_mfma_f32_16x16x32_f16 v[88:91], v[12:15], v[108:111], v[88:91]
  v_mfma_f32_16x16x32_f16 v[92:95], v[44:47], v[108:111], v[92:95]
  ds_read_b128 v[108:111], v159 offset:2784
  s_waitcnt lgkmcnt(7)
  v_mfma_f32_16x16x32_f16 v[88:91], v[8:11], v[112:115], v[88:91]
  v_mfma_f32_16x16x32_f16 v[92:95], v[40:43], v[112:115], v[92:95]
  ds_read_b128 v[112:115], v159 offset:2848
  s_waitcnt lgkmcnt(5)
  v_mfma_f32_16x16x32_f16 v[88:91], v[4:7], v[116:119], v[88:91]
  v_mfma_f32_16x16x32_f16 v[92:95], v[36:39], v[116:119], v[92:95]
  v_mfma_f32_16x16x32_f16 v[96:99], v[68:71], v[116:119], v[96:99]
  ds_read_b128 v[116:119], v159 offset:2912
  s_waitcnt lgkmcnt(5)
  v_mfma_f32_16x16x32_f16 v[92:95], v[32:35], v[120:123], v[92:95]
  v_mfma_f32_16x16x32_f16 v[96:99], v[64:67], v[120:123], v[96:99]
  ds_read_b128 v[120:123], v159 offset:2976
  s_waitcnt lgkmcnt(5)
  v_mfma_f32_16x16x32_f16 v[92:95], v[28:31], v[124:127], v[92:95]
  v_mfma_f32_16x16x32_f16 v[96:99], v[60:63], v[124:127], v[96:99]
  v_cvt_pk_bf16_f32 v148, v88, v89
  v_cvt_pk_bf16_f32 v149, v90, v91
  ds_write_b64 v160, v[148:149] offset:6656
  ds_read_b128 v[124:127], v159 offset:3040
  s_waitcnt lgkmcnt(6)
  v_mfma_f32_16x16x32_f16 v[92:95], v[24:27], v[104:107], v[92:95]
  v_mfma_f32_16x16x32_f16 v[96:99], v[56:59], v[104:107], v[96:99]
  ds_read_b128 v[104:107], v159 offset:3104
  s_waitcnt lgkmcnt(6)
  v_mfma_f32_16x16x32_f16 v[92:95], v[20:23], v[108:111], v[92:95]
  v_mfma_f32_16x16x32_f16 v[96:99], v[52:55], v[108:111], v[96:99]
  ds_read_b128 v[108:111], v159 offset:3168
  s_waitcnt lgkmcnt(6)
  v_mfma_f32_16x16x32_f16 v[92:95], v[16:19], v[112:115], v[92:95]
  v_mfma_f32_16x16x32_f16 v[96:99], v[48:51], v[112:115], v[96:99]
  ds_read_b128 v[112:115], v159 offset:3232
  s_waitcnt lgkmcnt(6)
  v_mfma_f32_16x16x32_f16 v[92:95], v[12:15], v[116:119], v[92:95]
  v_mfma_f32_16x16x32_f16 v[96:99], v[44:47], v[116:119], v[96:99]
  ds_read_b128 v[116:119], v159 offset:3296
  s_waitcnt lgkmcnt(6)
  v_mfma_f32_16x16x32_f16 v[92:95], v[8:11], v[120:123], v[92:95]
  v_mfma_f32_16x16x32_f16 v[96:99], v[40:43], v[120:123], v[96:99]
  ds_read_b128 v[120:123], v159 offset:3360
  s_waitcnt lgkmcnt(5)
  v_mfma_f32_16x16x32_f16 v[92:95], v[4:7], v[124:127], v[92:95]
  v_mfma_f32_16x16x32_f16 v[96:99], v[36:39], v[124:127], v[96:99]
  v_mfma_f32_16x16x32_f16 v[100:103], v[68:71], v[124:127], v[100:103]
  ds_read_b128 v[124:127], v159 offset:3424
  s_waitcnt lgkmcnt(5)
  v_mfma_f32_16x16x32_f16 v[96:99], v[32:35], v[104:107], v[96:99]
  v_mfma_f32_16x16x32_f16 v[100:103], v[64:67], v[104:107], v[100:103]
  ds_read_b128 v[104:107], v159 offset:3488
  s_waitcnt lgkmcnt(5)
  v_mfma_f32_16x16x32_f16 v[96:99], v[28:31], v[108:111], v[96:99]
  v_mfma_f32_16x16x32_f16 v[100:103], v[60:63], v[108:111], v[100:103]
  v_cvt_pk_bf16_f32 v150, v92, v93
  v_cvt_pk_bf16_f32 v151, v94, v95
  ds_write_b64 v160, v[150:151] offset:7168
  s_mov_b64 exec, 1
  ds_add_u32 v155, v156 offset:40
  s_mov_b64 exec, -1
  ds_read_b128 v[108:111], v159 offset:3552
  s_waitcnt lgkmcnt(7)
  v_mfma_f32_16x16x32_f16 v[96:99], v[24:27], v[112:115], v[96:99]
  v_mfma_f32_16x16x32_f16 v[100:103], v[56:59], v[112:115], v[100:103]
  ds_read_b128 v[112:115], v159 offset:3616
  s_waitcnt lgkmcnt(7)
  v_mfma_f32_16x16x32_f16 v[96:99], v[20:23], v[116:119], v[96:99]
  v_mfma_f32_16x16x32_f16 v[100:103], v[52:55], v[116:119], v[100:103]
  ds_read_b128 v[116:119], v159 offset:3680
  s_waitcnt lgkmcnt(7)
  v_mfma_f32_16x16x32_f16 v[96:99], v[16:19], v[120:123], v[96:99]
  v_mfma_f32_16x16x32_f16 v[100:103], v[48:51], v[120:123], v[100:103]
  ds_read_b128 v[120:123], v159 offset:3744
  s_waitcnt lgkmcnt(7)
  v_mfma_f32_16x16x32_f16 v[96:99], v[12:15], v[124:127], v[96:99]
  v_mfma_f32_16x16x32_f16 v[100:103], v[44:47], v[124:127], v[100:103]
  ds_read_b128 v[124:127], v159 offset:3808
  s_waitcnt lgkmcnt(7)
  v_mfma_f32_16x16x32_f16 v[96:99], v[8:11], v[104:107], v[96:99]
  v_mfma_f32_16x16x32_f16 v[100:103], v[40:43], v[104:107], v[100:103]
  ds_read_b128 v[104:107], v159 offset:3872
  s_waitcnt lgkmcnt(5)
  v_mfma_f32_16x16x32_f16 v[96:99], v[4:7], v[108:111], v[96:99]
  v_mfma_f32_16x16x32_f16 v[100:103], v[36:39], v[108:111], v[100:103]
  ds_read_b128 v[108:111], v159 offset:3936
  s_waitcnt lgkmcnt(5)
  v_mfma_f32_16x16x32_f16 v[100:103], v[32:35], v[112:115], v[100:103]
  ds_read_b128 v[112:115], v159 offset:4000
  s_waitcnt lgkmcnt(5)
  v_mfma_f32_16x16x32_f16 v[100:103], v[28:31], v[116:119], v[100:103]
  s_nop 0
  v_cvt_pk_bf16_f32 v148, v96, v97
  v_cvt_pk_bf16_f32 v149, v98, v99
  ds_write_b64 v160, v[148:149] offset:7680
  ds_read_b128 v[116:119], v159 offset:4064
  s_waitcnt lgkmcnt(6)
  v_mfma_f32_16x16x32_f16 v[100:103], v[24:27], v[120:123], v[100:103]
  s_waitcnt lgkmcnt(5)
  v_mfma_f32_16x16x32_f16 v[100:103], v[20:23], v[124:127], v[100:103]
  s_waitcnt lgkmcnt(4)
  v_mfma_f32_16x16x32_f16 v[100:103], v[16:19], v[104:107], v[100:103]
  s_waitcnt lgkmcnt(3)
  v_mfma_f32_16x16x32_f16 v[100:103], v[12:15], v[108:111], v[100:103]
  s_waitcnt lgkmcnt(2)
  v_mfma_f32_16x16x32_f16 v[100:103], v[8:11], v[112:115], v[100:103]
  s_waitcnt lgkmcnt(0)
  v_mfma_f32_16x16x32_f16 v[100:103], v[4:7], v[116:119], v[100:103]
  s_nop 7
  v_cvt_pk_bf16_f32 v150, v100, v101
  v_cvt_pk_bf16_f32 v151, v102, v103
  ds_write_b64 v160, v[150:151] offset:8192
  s_mov_b64 exec, 1
  ds_add_u32 v155, v156 offset:44
  s_mov_b64 exec, -1
  s_endpgm
K2_AUX:
  s_mov_b32 s10, 4194304
  s_mov_b32 s11, 0x20000
  s_mov_b32 s30, 7340032
  s_mov_b32 s31, 0x20000
  s_setprio 3
  v_mov_b32 v156, 0
  v_mov_b32 v157, 1
  v_lshlrev_b32 v158, 4, v0
  v_add_u32 v159, 34304, v158
  v_mov_b32 v160, 0x3f80
  v_mov_b32 v161, 0x3f800000
  s_mul_i32 s38, s3, 17152
  s_add_u32 s38, s38, 18176
  v_lshlrev_b32 v152, 4, v2
  v_add_u32 v152, s38, v152
  v_lshlrev_b32 v153, 6, v2
  v_add_u32 v153, s38, v153
  s_lshl_b32 s48, s34, 15
  s_cmp_ge_u32 s5, 28
  s_cselect_b32 s48, 0x70000000, s48
  v_lshlrev_b32 v154, 7, v0
  v_lshlrev_b32 v155, 3, v0
  s_waitcnt vmcnt(7)
  ds_write_b128 v152, v[84:87] offset:0
  s_waitcnt vmcnt(6)
  ds_write_b128 v152, v[88:91] offset:1024
  s_waitcnt vmcnt(5)
  ds_write_b128 v152, v[92:95] offset:2048
  s_waitcnt vmcnt(4)
  ds_write_b128 v152, v[96:99] offset:3072
  ds_read_b128 v[4:7], v153 offset:0
  ds_read_b128 v[8:11], v153 offset:16
  ds_read_b128 v[12:15], v153 offset:32
  ds_read_b128 v[16:19], v153 offset:48
  s_waitcnt vmcnt(0)
  s_waitcnt lgkmcnt(3)
  v_dot2_f32_bf16 v52, v4, v160, v20
  v_dot2_f32_bf16 v53, v4, v161, v21
  v_dot2_f32_bf16 v54, v5, v160, v22
  v_dot2_f32_bf16 v55, v5, v161, v23
  v_dot2_f32_bf16 v56, v6, v160, v24
  v_dot2_f32_bf16 v57, v6, v161, v25
  v_dot2_f32_bf16 v58, v7, v160, v26
  v_dot2_f32_bf16 v59, v7, v161, v27
  v_cvt_pk_bf16_f32 v116, v52, v53
  v_cvt_pk_bf16_f32 v117, v54, v55
  v_cvt_pk_bf16_f32 v118, v56, v57
  v_cvt_pk_bf16_f32 v119, v58, v59
  v_lshlrev_b32 v52, 16, v116
  v_and_b32 v53, 0xffff0000, v116
  v_lshlrev_b32 v54, 16, v117
  v_and_b32 v55, 0xffff0000, v117
  v_lshlrev_b32 v56, 16, v118
  v_and_b32 v57, 0xffff0000, v118
  v_lshlrev_b32 v58, 16, v119
  v_and_b32 v59, 0xffff0000, v119
  v_pk_mul_f32 v[52:53], v[52:53], v[28:29]
  v_pk_mul_f32 v[54:55], v[54:55], v[30:31]
  v_pk_mul_f32 v[56:57], v[56:57], v[32:33]
  v_pk_mul_f32 v[58:59], v[58:59], v[34:35]
  v_cvt_pk_bf16_f32 v116, v52, v53
  v_cvt_pk_bf16_f32 v117, v54, v55
  v_cvt_pk_bf16_f32 v118, v56, v57
  v_cvt_pk_bf16_f32 v119, v58, v59
  v_lshlrev_b32 v52, 16, v116
  v_and_b32 v53, 0xffff0000, v116
  v_lshlrev_b32 v54, 16, v117
  v_and_b32 v55, 0xffff0000, v117
  v_lshlrev_b32 v56, 16, v118
  v_and_b32 v57, 0xffff0000, v118
  v_lshlrev_b32 v58, 16, v119
  v_and_b32 v59, 0xffff0000, v119
  v_cvt_pk_f16_f32 v116, v52, v53
  v_cvt_pk_f16_f32 v117, v54, v55
  v_cvt_pk_f16_f32 v118, v56, v57
  v_cvt_pk_f16_f32 v119, v58, v59
  ds_write_b128 v158, v[116:119] offset:5632
  s_waitcnt lgkmcnt(3)
  v_dot2_f32_bf16 v60, v8, v160, v20
  v_dot2_f32_bf16 v61, v8, v161, v21
  v_dot2_f32_bf16 v62, v9, v160, v22
  v_dot2_f32_bf16 v63, v9, v161, v23
  v_dot2_f32_bf16 v64, v10, v160, v24
  v_dot2_f32_bf16 v65, v10, v161, v25
  v_dot2_f32_bf16 v66, v11, v160, v26
  v_dot2_f32_bf16 v67, v11, v161, v27
  v_cvt_pk_bf16_f32 v120, v60, v61
  v_cvt_pk_bf16_f32 v121, v62, v63
  v_cvt_pk_bf16_f32 v122, v64, v65
  v_cvt_pk_bf16_f32 v123, v66, v67
  v_lshlrev_b32 v60, 16, v120
  v_and_b32 v61, 0xffff0000, v120
  v_lshlrev_b32 v62, 16, v121
  v_and_b32 v63, 0xffff0000, v121
  v_lshlrev_b32 v64, 16, v122
  v_and_b32 v65, 0xffff0000, v122
  v_lshlrev_b32 v66, 16, v123
  v_and_b32 v67, 0xffff0000, v123
  v_pk_mul_f32 v[60:61], v[60:61], v[28:29]
  v_pk_mul_f32 v[62:63], v[62:63], v[30:31]
  v_pk_mul_f32 v[64:65], v[64:65], v[32:33]
  v_pk_mul_f32 v[66:67], v[66:67], v[34:35]
  v_cvt_pk_bf16_f32 v120, v60, v61
  v_cvt_pk_bf16_f32 v121, v62, v63
  v_cvt_pk_bf16_f32 v122, v64, v65
  v_cvt_pk_bf16_f32 v123, v66, v67
  v_lshlrev_b32 v60, 16, v120
  v_and_b32 v61, 0xffff0000, v120
  v_lshlrev_b32 v62, 16, v121
  v_and_b32 v63, 0xffff0000, v121
  v_lshlrev_b32 v64, 16, v122
  v_and_b32 v65, 0xffff0000, v122
  v_lshlrev_b32 v66, 16, v123
  v_and_b32 v67, 0xffff0000, v123
  v_cvt_pk_f16_f32 v120, v60, v61
  v_cvt_pk_f16_f32 v121, v62, v63
  v_cvt_pk_f16_f32 v122, v64, v65
  v_cvt_pk_f16_f32 v123, v66, v67
  ds_write_b128 v158, v[120:123] offset:22784
  s_waitcnt lgkmcnt(3)
  v_dot2_f32_bf16 v68, v12, v160, v20
  v_dot2_f32_bf16 v69, v12, v161, v21
  v_dot2_f32_bf16 v70, v13, v160, v22
  v_dot2_f32_bf16 v71, v13, v161, v23
  v_dot2_f32_bf16 v72, v14, v160, v24
  v_dot2_f32_bf16 v73, v14, v161, v25
  v_dot2_f32_bf16 v74, v15, v160, v26
  v_dot2_f32_bf16 v75, v15, v161, v27
  v_cvt_pk_bf16_f32 v124, v68, v69
  v_cvt_pk_bf16_f32 v125, v70, v71
  v_cvt_pk_bf16_f32 v126, v72, v73
  v_cvt_pk_bf16_f32 v127, v74, v75
  v_lshlrev_b32 v68, 16, v124
  v_and_b32 v69, 0xffff0000, v124
  v_lshlrev_b32 v70, 16, v125
  v_and_b32 v71, 0xffff0000, v125
  v_lshlrev_b32 v72, 16, v126
  v_and_b32 v73, 0xffff0000, v126
  v_lshlrev_b32 v74, 16, v127
  v_and_b32 v75, 0xffff0000, v127
  v_pk_mul_f32 v[68:69], v[68:69], v[28:29]
  v_pk_mul_f32 v[70:71], v[70:71], v[30:31]
  v_pk_mul_f32 v[72:73], v[72:73], v[32:33]
  v_pk_mul_f32 v[74:75], v[74:75], v[34:35]
  v_cvt_pk_bf16_f32 v124, v68, v69
  v_cvt_pk_bf16_f32 v125, v70, v71
  v_cvt_pk_bf16_f32 v126, v72, v73
  v_cvt_pk_bf16_f32 v127, v74, v75
  v_lshlrev_b32 v68, 16, v124
  v_and_b32 v69, 0xffff0000, v124
  v_lshlrev_b32 v70, 16, v125
  v_and_b32 v71, 0xffff0000, v125
  v_lshlrev_b32 v72, 16, v126
  v_and_b32 v73, 0xffff0000, v126
  v_lshlrev_b32 v74, 16, v127
  v_and_b32 v75, 0xffff0000, v127
  v_cvt_pk_f16_f32 v124, v68, v69
  v_cvt_pk_f16_f32 v125, v70, v71
  v_cvt_pk_f16_f32 v126, v72, v73
  v_cvt_pk_f16_f32 v127, v74, v75
  ds_write_b128 v159, v[124:127] offset:5632
  s_waitcnt lgkmcnt(3)
  v_dot2_f32_bf16 v76, v16, v160, v20
  v_dot2_f32_bf16 v77, v16, v161, v21
  v_dot2_f32_bf16 v78, v17, v160, v22
  v_dot2_f32_bf16 v79, v17, v161, v23
  v_dot2_f32_bf16 v80, v18, v160, v24
  v_dot2_f32_bf16 v81, v18, v161, v25
  v_dot2_f32_bf16 v82, v19, v160, v26
  v_dot2_f32_bf16 v83, v19, v161, v27
  v_cvt_pk_bf16_f32 v128, v76, v77
  v_cvt_pk_bf16_f32 v129, v78, v79
  v_cvt_pk_bf16_f32 v130, v80, v81
  v_cvt_pk_bf16_f32 v131, v82, v83
  v_lshlrev_b32 v76, 16, v128
  v_and_b32 v77, 0xffff0000, v128
  v_lshlrev_b32 v78, 16, v129
  v_and_b32 v79, 0xffff0000, v129
  v_lshlrev_b32 v80, 16, v130
  v_and_b32 v81, 0xffff0000, v130
  v_lshlrev_b32 v82, 16, v131
  v_and_b32 v83, 0xffff0000, v131
  v_pk_mul_f32 v[76:77], v[76:77], v[28:29]
  v_pk_mul_f32 v[78:79], v[78:79], v[30:31]
  v_pk_mul_f32 v[80:81], v[80:81], v[32:33]
  v_pk_mul_f32 v[82:83], v[82:83], v[34:35]
  v_cvt_pk_bf16_f32 v128, v76, v77
  v_cvt_pk_bf16_f32 v129, v78, v79
  v_cvt_pk_bf16_f32 v130, v80, v81
  v_cvt_pk_bf16_f32 v131, v82, v83
  v_lshlrev_b32 v76, 16, v128
  v_and_b32 v77, 0xffff0000, v128
  v_lshlrev_b32 v78, 16, v129
  v_and_b32 v79, 0xffff0000, v129
  v_lshlrev_b32 v80, 16, v130
  v_and_b32 v81, 0xffff0000, v130
  v_lshlrev_b32 v82, 16, v131
  v_and_b32 v83, 0xffff0000, v131
  v_cvt_pk_f16_f32 v128, v76, v77
  v_cvt_pk_f16_f32 v129, v78, v79
  v_cvt_pk_f16_f32 v130, v80, v81
  v_cvt_pk_f16_f32 v131, v82, v83
  ds_write_b128 v159, v[128:131] offset:22784
  s_mov_b64 exec, 1
  ds_add_u32 v156, v157 offset:12
  s_mov_b64 exec, -1
  s_waitcnt lgkmcnt(0)
  s_lshl_b32 s52, s36, 16
  s_mov_b32 s53, s52
  s_and_b32 s54, s36, 0xffff0000
  s_mov_b32 s55, s54
  s_lshl_b32 s56, s37, 16
  s_mov_b32 s57, s56
  s_and_b32 s58, s37, 0xffff0000
  s_mov_b32 s59, s58
  v_pk_mul_f32 v[116:117], v[52:53], s[52:53]
  v_pk_mul_f32 v[118:119], v[54:55], s[52:53]
  v_pk_mul_f32 v[120:121], v[56:57], s[52:53]
  v_pk_mul_f32 v[122:123], v[58:59], s[52:53]
  v_cvt_pk_bf16_f32 v84, v116, v117
  v_cvt_pk_bf16_f32 v85, v118, v119
  v_cvt_pk_bf16_f32 v86, v120, v121
  v_cvt_pk_bf16_f32 v87, v122, v123
  v_lshlrev_b32 v116, 16, v84
  v_and_b32 v117, 0xffff0000, v84
  v_lshlrev_b32 v118, 16, v85
  v_and_b32 v119, 0xffff0000, v85
  v_lshlrev_b32 v120, 16, v86
  v_and_b32 v121, 0xffff0000, v86
  v_lshlrev_b32 v122, 16, v87
  v_and_b32 v123, 0xffff0000, v87
  v_lshlrev_b32 v84, 16, v4
  v_and_b32 v85, 0xffff0000, v4
  v_lshlrev_b32 v86, 16, v5
  v_and_b32 v87, 0xffff0000, v5
  v_lshlrev_b32 v88, 16, v6
  v_and_b32 v89, 0xffff0000, v6
  v_lshlrev_b32 v90, 16, v7
  v_and_b32 v91, 0xffff0000, v7
  v_pk_mul_f32 v[124:125], v[60:61], s[54:55]
  v_pk_mul_f32 v[126:127], v[62:63], s[54:55]
  v_pk_mul_f32 v[128:129], v[64:65], s[54:55]
  v_pk_mul_f32 v[130:131], v[66:67], s[54:55]
  v_cvt_pk_bf16_f32 v92, v124, v125
  v_cvt_pk_bf16_f32 v93, v126, v127
  v_cvt_pk_bf16_f32 v94, v128, v129
  v_cvt_pk_bf16_f32 v95, v130, v131
  v_lshlrev_b32 v124, 16, v92
  v_and_b32 v125, 0xffff0000, v92
  v_lshlrev_b32 v126, 16, v93
  v_and_b32 v127, 0xffff0000, v93
  v_lshlrev_b32 v128, 16, v94
  v_and_b32 v129, 0xffff0000, v94
  v_lshlrev_b32 v130, 16, v95
  v_and_b32 v131, 0xffff0000, v95
  v_lshlrev_b32 v92, 16, v8
  v_and_b32 v93, 0xffff0000, v8
  v_lshlrev_b32 v94, 16, v9
  v_and_b32 v95, 0xffff0000, v9
  v_lshlrev_b32 v96, 16, v10
  v_and_b32 v97, 0xffff0000, v10
  v_lshlrev_b32 v98, 16, v11
  v_and_b32 v99, 0xffff0000, v11
  v_pk_mul_f32 v[132:133], v[68:69], s[56:57]
  v_pk_mul_f32 v[134:135], v[70:71], s[56:57]
  v_pk_mul_f32 v[136:137], v[72:73], s[56:57]
  v_pk_mul_f32 v[138:139], v[74:75], s[56:57]
  v_cvt_pk_bf16_f32 v100, v132, v133
  v_cvt_pk_bf16_f32 v101, v134, v135
  v_cvt_pk_bf16_f32 v102, v136, v137
  v_cvt_pk_bf16_f32 v103, v138, v139
  v_lshlrev_b32 v132, 16, v100
  v_and_b32 v133, 0xffff0000, v100
  v_lshlrev_b32 v134, 16, v101
  v_and_b32 v135, 0xffff0000, v101
  v_lshlrev_b32 v136, 16, v102
  v_and_b32 v137, 0xffff0000, v102
  v_lshlrev_b32 v138, 16, v103
  v_and_b32 v139, 0xffff0000, v103
  v_lshlrev_b32 v100, 16, v12
  v_and_b32 v101, 0xffff0000, v12
  v_lshlrev_b32 v102, 16, v13
  v_and_b32 v103, 0xffff0000, v13
  v_lshlrev_b32 v104, 16, v14
  v_and_b32 v105, 0xffff0000, v14
  v_lshlrev_b32 v106, 16, v15
  v_and_b32 v107, 0xffff0000, v15
  v_pk_mul_f32 v[140:141], v[76:77], s[58:59]
  v_pk_mul_f32 v[142:143], v[78:79], s[58:59]
  v_pk_mul_f32 v[144:145], v[80:81], s[58:59]
  v_pk_mul_f32 v[146:147], v[82:83], s[58:59]
  v_cvt_pk_bf16_f32 v108, v140, v141
  v_cvt_pk_bf16_f32 v109, v142, v143
  v_cvt_pk_bf16_f32 v110, v144, v145
  v_cvt_pk_bf16_f32 v111, v146, v147
  v_lshlrev_b32 v140, 16, v108
  v_and_b32 v141, 0xffff0000, v108
  v_lshlrev_b32 v142, 16, v109
  v_and_b32 v143, 0xffff0000, v109
  v_lshlrev_b32 v144, 16, v110
  v_and_b32 v145, 0xffff0000, v110
  v_lshlrev_b32 v146, 16, v111
  v_and_b32 v147, 0xffff0000, v111
  v_lshlrev_b32 v108, 16, v16
  v_and_b32 v109, 0xffff0000, v16
  v_lshlrev_b32 v110, 16, v17
  v_and_b32 v111, 0xffff0000, v17
  v_lshlrev_b32 v112, 16, v18
  v_and_b32 v113, 0xffff0000, v18
  v_lshlrev_b32 v114, 16, v19
  v_and_b32 v115, 0xffff0000, v19
  s_setprio 1
  s_lshl_b32 s47, s6, 14
  s_add_u32 s47, s47, 10485760
  s_add_u32 s48, s47, 8192
  v_add_u32 v149, 4096, v158
  s_lshl_b32 s38, s3, 2
  v_mov_b32 v152, s38
K2_SPINY:
  s_sleep 1
  ds_read_b32 v150, v152 offset:32
  s_waitcnt lgkmcnt(0)
  v_readfirstlane_b32 s38, v150
  s_nop 1
  s_cmp_lt_u32 s38, 4
  s_cbranch_scc1 K2_SPINY
  ds_read_b128 v[4:7], v158 offset:9728
  ds_read_b128 v[8:11], v158 offset:26880
  ds_read_b128 v[12:15], v159 offset:9728
  ds_read_b128 v[16:19], v159 offset:26880
  s_cmp_eq_u32 s3, 3
  s_cbranch_scc1 K2_EPID
  v_mov_b32 v48, s64
  v_mov_b32 v49, s65
  v_mov_b32 v50, s66
  v_mov_b32 v51, s67
  s_waitcnt lgkmcnt(3)
  v_lshlrev_b32 v20, 16, v4
  v_and_b32 v21, 0xffff0000, v4
  v_lshlrev_b32 v22, 16, v5
  v_and_b32 v23, 0xffff0000, v5
  v_lshlrev_b32 v24, 16, v6
  v_and_b32 v25, 0xffff0000, v6
  v_lshlrev_b32 v26, 16, v7
  v_and_b32 v27, 0xffff0000, v7
  v_fmac_f32 v116, v48, v20
  v_fmac_f32 v117, v48, v21
  v_fmac_f32 v118, v48, v22
  v_fmac_f32 v119, v48, v23
  v_fmac_f32 v120, v48, v24
  v_fmac_f32 v121, v48, v25
  v_fmac_f32 v122, v48, v26
  v_fmac_f32 v123, v48, v27
  v_cvt_pk_bf16_f32 v4, v116, v117
  v_cvt_pk_bf16_f32 v5, v118, v119
  v_cvt_pk_bf16_f32 v6, v120, v121
  v_cvt_pk_bf16_f32 v7, v122, v123
  v_lshlrev_b32 v20, 16, v4
  v_and_b32 v21, 0xffff0000, v4
  v_lshlrev_b32 v22, 16, v5
  v_and_b32 v23, 0xffff0000, v5
  v_lshlrev_b32 v24, 16, v6
  v_and_b32 v25, 0xffff0000, v6
  v_lshlrev_b32 v26, 16, v7
  v_and_b32 v27, 0xffff0000, v7
  v_add_f32 v84, v84, v20
  v_add_f32 v85, v85, v21
  v_add_f32 v86, v86, v22
  v_add_f32 v87, v87, v23
  v_add_f32 v88, v88, v24
  v_add_f32 v89, v89, v25
  v_add_f32 v90, v90, v26
  v_add_f32 v91, v91, v27
  v_cvt_pk_bf16_f32 v4, v84, v85
  v_cvt_pk_bf16_f32 v5, v86, v87
  v_cvt_pk_bf16_f32 v6, v88, v89
  v_cvt_pk_bf16_f32 v7, v90, v91
  v_lshlrev_b32 v20, 16, v4
  v_and_b32 v21, 0xffff0000, v4
  v_lshlrev_b32 v22, 16, v5
  v_and_b32 v23, 0xffff0000, v5
  v_lshlrev_b32 v24, 16, v6
  v_and_b32 v25, 0xffff0000, v6
  v_lshlrev_b32 v26, 16, v7
  v_and_b32 v27, 0xffff0000, v7
  v_add_f32 v52, v52, v20
  v_add_f32 v53, v53, v21
  v_add_f32 v54, v54, v22
  v_add_f32 v55, v55, v23
  v_add_f32 v56, v56, v24
  v_add_f32 v57, v57, v25
  v_add_f32 v58, v58, v26
  v_add_f32 v59, v59, v27
  s_waitcnt lgkmcnt(2)
  v_lshlrev_b32 v20, 16, v8
  v_and_b32 v21, 0xffff0000, v8
  v_lshlrev_b32 v22, 16, v9
  v_and_b32 v23, 0xffff0000, v9
  v_lshlrev_b32 v24, 16, v10
  v_and_b32 v25, 0xffff0000, v10
  v_lshlrev_b32 v26, 16, v11
  v_and_b32 v27, 0xffff0000, v11
  v_fmac_f32 v124, v49, v20
  v_fmac_f32 v125, v49, v21
  v_fmac_f32 v126, v49, v22
  v_fmac_f32 v127, v49, v23
  v_fmac_f32 v128, v49, v24
  v_fmac_f32 v129, v49, v25
  v_fmac_f32 v130, v49, v26
  v_fmac_f32 v131, v49, v27
  v_cvt_pk_bf16_f32 v8, v124, v125
  v_cvt_pk_bf16_f32 v9, v126, v127
  v_cvt_pk_bf16_f32 v10, v128, v129
  v_cvt_pk_bf16_f32 v11, v130, v131
  v_lshlrev_b32 v20, 16, v8
  v_and_b32 v21, 0xffff0000, v8
  v_lshlrev_b32 v22, 16, v9
  v_and_b32 v23, 0xffff0000, v9
  v_lshlrev_b32 v24, 16, v10
  v_and_b32 v25, 0xffff0000, v10
  v_lshlrev_b32 v26, 16, v11
  v_and_b32 v27, 0xffff0000, v11
  v_add_f32 v92, v92, v20
  v_add_f32 v93, v93, v21
  v_add_f32 v94, v94, v22
  v_add_f32 v95, v95, v23
  v_add_f32 v96, v96, v24
  v_add_f32 v97, v97, v25
  v_add_f32 v98, v98, v26
  v_add_f32 v99, v99, v27
  v_cvt_pk_bf16_f32 v8, v92, v93
  v_cvt_pk_bf16_f32 v9, v94, v95
  v_cvt_pk_bf16_f32 v10, v96, v97
  v_cvt_pk_bf16_f32 v11, v98, v99
  v_lshlrev_b32 v20, 16, v8
  v_and_b32 v21, 0xffff0000, v8
  v_lshlrev_b32 v22, 16, v9
  v_and_b32 v23, 0xffff0000, v9
  v_lshlrev_b32 v24, 16, v10
  v_and_b32 v25, 0xffff0000, v10
  v_lshlrev_b32 v26, 16, v11
  v_and_b32 v27, 0xffff0000, v11
  v_add_f32 v60, v60, v20
  v_add_f32 v61, v61, v21
  v_add_f32 v62, v62, v22
  v_add_f32 v63, v63, v23
  v_add_f32 v64, v64, v24
  v_add_f32 v65, v65, v25
  v_add_f32 v66, v66, v26
  v_add_f32 v67, v67, v27
  s_waitcnt lgkmcnt(1)
  v_lshlrev_b32 v20, 16, v12
  v_and_b32 v21, 0xffff0000, v12
  v_lshlrev_b32 v22, 16, v13
  v_and_b32 v23, 0xffff0000, v13
  v_lshlrev_b32 v24, 16, v14
  v_and_b32 v25, 0xffff0000, v14
  v_lshlrev_b32 v26, 16, v15
  v_and_b32 v27, 0xffff0000, v15
  v_fmac_f32 v132, v50, v20
  v_fmac_f32 v133, v50, v21
  v_fmac_f32 v134, v50, v22
  v_fmac_f32 v135, v50, v23
  v_fmac_f32 v136, v50, v24
  v_fmac_f32 v137, v50, v25
  v_fmac_f32 v138, v50, v26
  v_fmac_f32 v139, v50, v27
  v_cvt_pk_bf16_f32 v12, v132, v133
  v_cvt_pk_bf16_f32 v13, v134, v135
  v_cvt_pk_bf16_f32 v14, v136, v137
  v_cvt_pk_bf16_f32 v15, v138, v139
  v_lshlrev_b32 v20, 16, v12
  v_and_b32 v21, 0xffff0000, v12
  v_lshlrev_b32 v22, 16, v13
  v_and_b32 v23, 0xffff0000, v13
  v_lshlrev_b32 v24, 16, v14
  v_and_b32 v25, 0xffff0000, v14
  v_lshlrev_b32 v26, 16, v15
  v_and_b32 v27, 0xffff0000, v15
  v_add_f32 v100, v100, v20
  v_add_f32 v101, v101, v21
  v_add_f32 v102, v102, v22
  v_add_f32 v103, v103, v23
  v_add_f32 v104, v104, v24
  v_add_f32 v105, v105, v25
  v_add_f32 v106, v106, v26
  v_add_f32 v107, v107, v27
  v_cvt_pk_bf16_f32 v12, v100, v101
  v_cvt_pk_bf16_f32 v13, v102, v103
  v_cvt_pk_bf16_f32 v14, v104, v105
  v_cvt_pk_bf16_f32 v15, v106, v107
  v_lshlrev_b32 v20, 16, v12
  v_and_b32 v21, 0xffff0000, v12
  v_lshlrev_b32 v22, 16, v13
  v_and_b32 v23, 0xffff0000, v13
  v_lshlrev_b32 v24, 16, v14
  v_and_b32 v25, 0xffff0000, v14
  v_lshlrev_b32 v26, 16, v15
  v_and_b32 v27, 0xffff0000, v15
  v_add_f32 v68, v68, v20
  v_add_f32 v69, v69, v21
  v_add_f32 v70, v70, v22
  v_add_f32 v71, v71, v23
  v_add_f32 v72, v72, v24
  v_add_f32 v73, v73, v25
  v_add_f32 v74, v74, v26
  v_add_f32 v75, v75, v27
  s_waitcnt lgkmcnt(0)
  v_lshlrev_b32 v20, 16, v16
  v_and_b32 v21, 0xffff0000, v16
  v_lshlrev_b32 v22, 16, v17
  v_and_b32 v23, 0xffff0000, v17
  v_lshlrev_b32 v24, 16, v18
  v_and_b32 v25, 0xffff0000, v18
  v_lshlrev_b32 v26, 16, v19
  v_and_b32 v27, 0xffff0000, v19
  v_fmac_f32 v140, v51, v20
  v_fmac_f32 v141, v51, v21
  v_fmac_f32 v142, v51, v22
  v_fmac_f32 v143, v51, v23
  v_fmac_f32 v144, v51, v24
  v_fmac_f32 v145, v51, v25
  v_fmac_f32 v146, v51, v26
  v_fmac_f32 v147, v51, v27
  v_cvt_pk_bf16_f32 v16, v140, v141
  v_cvt_pk_bf16_f32 v17, v142, v143
  v_cvt_pk_bf16_f32 v18, v144, v145
  v_cvt_pk_bf16_f32 v19, v146, v147
  v_lshlrev_b32 v20, 16, v16
  v_and_b32 v21, 0xffff0000, v16
  v_lshlrev_b32 v22, 16, v17
  v_and_b32 v23, 0xffff0000, v17
  v_lshlrev_b32 v24, 16, v18
  v_and_b32 v25, 0xffff0000, v18
  v_lshlrev_b32 v26, 16, v19
  v_and_b32 v27, 0xffff0000, v19
  v_add_f32 v108, v108, v20
  v_add_f32 v109, v109, v21
  v_add_f32 v110, v110, v22
  v_add_f32 v111, v111, v23
  v_add_f32 v112, v112, v24
  v_add_f32 v113, v113, v25
  v_add_f32 v114, v114, v26
  v_add_f32 v115, v115, v27
  v_cvt_pk_bf16_f32 v16, v108, v109
  v_cvt_pk_bf16_f32 v17, v110, v111
  v_cvt_pk_bf16_f32 v18, v112, v113
  v_cvt_pk_bf16_f32 v19, v114, v115
  v_lshlrev_b32 v20, 16, v16
  v_and_b32 v21, 0xffff0000, v16
  v_lshlrev_b32 v22, 16, v17
  v_and_b32 v23, 0xffff0000, v17
  v_lshlrev_b32 v24, 16, v18
  v_and_b32 v25, 0xffff0000, v18
  v_lshlrev_b32 v26, 16, v19
  v_and_b32 v27, 0xffff0000, v19
  v_add_f32 v76, v76, v20
  v_add_f32 v77, v77, v21
  v_add_f32 v78, v78, v22
  v_add_f32 v79, v79, v23
  v_add_f32 v80, v80, v24
  v_add_f32 v81, v81, v25
  v_add_f32 v82, v82, v26
  v_add_f32 v83, v83, v27
  s_branch K2_EPIE
K2_EPID:
  s_lshr_b32 s68, s64, 16
  s_lshr_b32 s69, s65, 16
  s_lshr_b32 s70, s66, 16
  s_lshr_b32 s71, s67, 16
  s_waitcnt lgkmcnt(3)
  v_dot2_f32_bf16 v116, v4, s68, v116
  v_dot2_f32_bf16 v117, v4, s64, v117
  v_dot2_f32_bf16 v118, v5, s68, v118
  v_dot2_f32_bf16 v119, v5, s64, v119
  v_dot2_f32_bf16 v120, v6, s68, v120
  v_dot2_f32_bf16 v121, v6, s64, v121
  v_dot2_f32_bf16 v122, v7, s68, v122
  v_dot2_f32_bf16 v123, v7, s64, v123
  s_waitcnt lgkmcnt(2)
  v_dot2_f32_bf16 v124, v8, s69, v124
  v_dot2_f32_bf16 v125, v8, s65, v125
  v_dot2_f32_bf16 v126, v9, s69, v126
  v_dot2_f32_bf16 v127, v9, s65, v127
  v_dot2_f32_bf16 v128, v10, s69, v128
  v_dot2_f32_bf16 v129, v10, s65, v129
  v_dot2_f32_bf16 v130, v11, s69, v130
  v_dot2_f32_bf16 v131, v11, s65, v131
  s_waitcnt lgkmcnt(1)
  v_dot2_f32_bf16 v132, v12, s70, v132
  v_dot2_f32_bf16 v133, v12, s66, v133
  v_dot2_f32_bf16 v134, v13, s70, v134
  v_dot2_f32_bf16 v135, v13, s66, v135
  v_dot2_f32_bf16 v136, v14, s70, v136
  v_dot2_f32_bf16 v137, v14, s66, v137
  v_dot2_f32_bf16 v138, v15, s70, v138
  v_dot2_f32_bf16 v139, v15, s66, v139
  s_waitcnt lgkmcnt(0)
  v_dot2_f32_bf16 v140, v16, s71, v140
  v_dot2_f32_bf16 v141, v16, s67, v141
  v_dot2_f32_bf16 v142, v17, s71, v142
  v_dot2_f32_bf16 v143, v17, s67, v143
  v_dot2_f32_bf16 v144, v18, s71, v144
  v_dot2_f32_bf16 v145, v18, s67, v145
  v_dot2_f32_bf16 v146, v19, s71, v146
  v_dot2_f32_bf16 v147, v19, s67, v147
  v_cvt_pk_bf16_f32 v4, v116, v117
  v_cvt_pk_bf16_f32 v5, v118, v119
  v_cvt_pk_bf16_f32 v6, v120, v121
  v_cvt_pk_bf16_f32 v7, v122, v123
  v_cvt_pk_bf16_f32 v8, v124, v125
  v_cvt_pk_bf16_f32 v9, v126, v127
  v_cvt_pk_bf16_f32 v10, v128, v129
  v_cvt_pk_bf16_f32 v11, v130, v131
  v_cvt_pk_bf16_f32 v12, v132, v133
  v_cvt_pk_bf16_f32 v13, v134, v135
  v_cvt_pk_bf16_f32 v14, v136, v137
  v_cvt_pk_bf16_f32 v15, v138, v139
  v_cvt_pk_bf16_f32 v16, v140, v141
  v_cvt_pk_bf16_f32 v17, v142, v143
  v_cvt_pk_bf16_f32 v18, v144, v145
  v_cvt_pk_bf16_f32 v19, v146, v147
  v_dot2_f32_bf16 v84, v4, v160, v84
  v_dot2_f32_bf16 v85, v4, v161, v85
  v_dot2_f32_bf16 v86, v5, v160, v86
  v_dot2_f32_bf16 v87, v5, v161, v87
  v_dot2_f32_bf16 v88, v6, v160, v88
  v_dot2_f32_bf16 v89, v6, v161, v89
  v_dot2_f32_bf16 v90, v7, v160, v90
  v_dot2_f32_bf16 v91, v7, v161, v91
  v_dot2_f32_bf16 v92, v8, v160, v92
  v_dot2_f32_bf16 v93, v8, v161, v93
  v_dot2_f32_bf16 v94, v9, v160, v94
  v_dot2_f32_bf16 v95, v9, v161, v95
  v_dot2_f32_bf16 v96, v10, v160, v96
  v_dot2_f32_bf16 v97, v10, v161, v97
  v_dot2_f32_bf16 v98, v11, v160, v98
  v_dot2_f32_bf16 v99, v11, v161, v99
  v_dot2_f32_bf16 v100, v12, v160, v100
  v_dot2_f32_bf16 v101, v12, v161, v101
  v_dot2_f32_bf16 v102, v13, v160, v102
  v_dot2_f32_bf16 v103, v13, v161, v103
  v_dot2_f32_bf16 v104, v14, v160, v104
  v_dot2_f32_bf16 v105, v14, v161, v105
  v_dot2_f32_bf16 v106, v15, v160, v106
  v_dot2_f32_bf16 v107, v15, v161, v107
  v_dot2_f32_bf16 v108, v16, v160, v108
  v_dot2_f32_bf16 v109, v16, v161, v109
  v_dot2_f32_bf16 v110, v17, v160, v110
  v_dot2_f32_bf16 v111, v17, v161, v111
  v_dot2_f32_bf16 v112, v18, v160, v112
  v_dot2_f32_bf16 v113, v18, v161, v113
  v_dot2_f32_bf16 v114, v19, v160, v114
  v_dot2_f32_bf16 v115, v19, v161, v115
  v_cvt_pk_bf16_f32 v4, v84, v85
  v_cvt_pk_bf16_f32 v5, v86, v87
  v_cvt_pk_bf16_f32 v6, v88, v89
  v_cvt_pk_bf16_f32 v7, v90, v91
  v_cvt_pk_bf16_f32 v8, v92, v93
  v_cvt_pk_bf16_f32 v9, v94, v95
  v_cvt_pk_bf16_f32 v10, v96, v97
  v_cvt_pk_bf16_f32 v11, v98, v99
  v_cvt_pk_bf16_f32 v12, v100, v101
  v_cvt_pk_bf16_f32 v13, v102, v103
  v_cvt_pk_bf16_f32 v14, v104, v105
  v_cvt_pk_bf16_f32 v15, v106, v107
  v_cvt_pk_bf16_f32 v16, v108, v109
  v_cvt_pk_bf16_f32 v17, v110, v111
  v_cvt_pk_bf16_f32 v18, v112, v113
  v_cvt_pk_bf16_f32 v19, v114, v115
  v_dot2_f32_bf16 v52, v4, v160, v52
  v_dot2_f32_bf16 v53, v4, v161, v53
  v_dot2_f32_bf16 v54, v5, v160, v54
  v_dot2_f32_bf16 v55, v5, v161, v55
  v_dot2_f32_bf16 v56, v6, v160, v56
  v_dot2_f32_bf16 v57, v6, v161, v57
  v_dot2_f32_bf16 v58, v7, v160, v58
  v_dot2_f32_bf16 v59, v7, v161, v59
  v_dot2_f32_bf16 v60, v8, v160, v60
  v_dot2_f32_bf16 v61, v8, v161, v61
  v_dot2_f32_bf16 v62, v9, v160, v62
  v_dot2_f32_bf16 v63, v9, v161, v63
  v_dot2_f32_bf16 v64, v10, v160, v64
  v_dot2_f32_bf16 v65, v10, v161, v65
  v_dot2_f32_bf16 v66, v11, v160, v66
  v_dot2_f32_bf16 v67, v11, v161, v67
  v_dot2_f32_bf16 v68, v12, v160, v68
  v_dot2_f32_bf16 v69, v12, v161, v69
  v_dot2_f32_bf16 v70, v13, v160, v70
  v_dot2_f32_bf16 v71, v13, v161, v71
  v_dot2_f32_bf16 v72, v14, v160, v72
  v_dot2_f32_bf16 v73, v14, v161, v73
  v_dot2_f32_bf16 v74, v15, v160, v74
  v_dot2_f32_bf16 v75, v15, v161, v75
  v_dot2_f32_bf16 v76, v16, v160, v76
  v_dot2_f32_bf16 v77, v16, v161, v77
  v_dot2_f32_bf16 v78, v17, v160, v78
  v_dot2_f32_bf16 v79, v17, v161, v79
  v_dot2_f32_bf16 v80, v18, v160, v80
  v_dot2_f32_bf16 v81, v18, v161, v81
  v_dot2_f32_bf16 v82, v19, v160, v82
  v_dot2_f32_bf16 v83, v19, v161, v83
  s_nop 2
K2_EPIE:
  v_cvt_pk_bf16_f32 v116, v52, v53
  v_cvt_pk_bf16_f32 v117, v54, v55
  v_cvt_pk_bf16_f32 v118, v56, v57
  v_cvt_pk_bf16_f32 v119, v58, v59
  buffer_store_dwordx4 v[116:119], v158, s[12:15], s47 offen sc1
  v_cvt_pk_bf16_f32 v120, v60, v61
  v_cvt_pk_bf16_f32 v121, v62, v63
  v_cvt_pk_bf16_f32 v122, v64, v65
  v_cvt_pk_bf16_f32 v123, v66, v67
  buffer_store_dwordx4 v[120:123], v149, s[12:15], s47 offen sc1
  v_cvt_pk_bf16_f32 v124, v68, v69
  v_cvt_pk_bf16_f32 v125, v70, v71
  v_cvt_pk_bf16_f32 v126, v72, v73
  v_cvt_pk_bf16_f32 v127, v74, v75
  buffer_store_dwordx4 v[124:127], v158, s[12:15], s48 offen sc1
  v_cvt_pk_bf16_f32 v128, v76, v77
  v_cvt_pk_bf16_f32 v129, v78, v79
  v_cvt_pk_bf16_f32 v130, v80, v81
  v_cvt_pk_bf16_f32 v131, v82, v83
  buffer_store_dwordx4 v[128:131], v149, s[12:15], s48 offen sc1
  s_cmp_lg_u32 s3, 3
  s_cbranch_scc1 K2_AEND
K2_SPINK:
  ds_read_b64 v[36:37], v156 offset:24
  s_waitcnt lgkmcnt(0)
  v_readfirstlane_b32 s38, v37
  v_readfirstlane_b32 s51, v36
  s_nop 1
  s_cmp_eq_u32 s38, 0
  s_cbranch_scc1 K2_SPINK
  v_mul_u32_u24 v149, 17152, v2
  s_lshl_b32 s38, s51, 1
  v_add_u32 v149, s38, v149
  v_lshlrev_b32 v150, 1, v2
  s_lshl_b32 s46, s6, 3
  s_add_u32 s46, s46, 8388608
  s_mov_b64 exec, 15
  ds_read_u16 v152, v149 offset:9728
  v_mov_b32 v153, s64
  v_writelane_b32 v153, s65, 1
  v_writelane_b32 v153, s66, 2
  v_writelane_b32 v153, s67, 3
  s_waitcnt lgkmcnt(0)
  v_lshlrev_b32 v152, 16, v152
  v_mul_f32 v152, v152, v153
  v_lshrrev_b32 v152, 16, v152
  buffer_store_short v152, v150, s[12:15], s46 offen sc1
  s_mov_b64 exec, -1
K2_AEND:
  s_endpgm
K2_FFN:
  s_mov_b32 s10, 4194304
  s_mov_b32 s11, 0x20000
  v_lshrrev_b32 v122, 4, v2
  v_lshlrev_b32 v122, 4, v122
  s_lshl_b32 s40, s37, 9
  s_lshl_b32 s41, s3, 7
  s_add_u32 s40, s40, s41
  s_waitcnt vmcnt(0)
  v_max3_u32 v112, v112, v113, v114
  v_max_u32 v112, v112, v115
  s_nop 1
  v_max_u32_dpp v112, v112, v112 row_shr:1 row_mask:0xf bank_mask:0xf bound_ctrl:0
  s_nop 1
  v_max_u32_dpp v112, v112, v112 row_shr:2 row_mask:0xf bank_mask:0xf bound_ctrl:0
  s_nop 1
  v_max_u32_dpp v112, v112, v112 row_shr:4 row_mask:0xf bank_mask:0xf bound_ctrl:0
  s_nop 1
  v_max_u32_dpp v112, v112, v112 row_shr:8 row_mask:0xf bank_mask:0xf bound_ctrl:0
  s_nop 1
  v_max_u32_dpp v112, v112, v112 row_bcast:15 row_mask:0xa bank_mask:0xf
  s_nop 1
  v_max_u32_dpp v112, v112, v112 row_bcast:31 row_mask:0xc bank_mask:0xf
  s_nop 0
  v_readlane_b32 s50, v112, 63
  s_nop 0
  s_and_b32 s51, s50, 0xffff
  s_sub_u32 s51, 2047, s51
  v_mov_b32 v112, s51
  v_mov_b32 v113, 1
  ds_write_b64 v124, v[112:113] offset:24
  s_cmp_ge_u32 s5, 28
  s_cbranch_scc1 K2_END
  s_lshl_b32 s38, s51, 11
  s_add_u32 s38, s38, s40
  s_lshl_b32 s39, s51, 2
  s_add_u32 s39, s39, 6291456
  s_add_u32 s49, s39, 8192
  buffer_load_dwordx4 v[68:71], v122, s[8:11], s38 offen
  buffer_load_dwordx4 v[72:75], v122, s[8:11], s38 offen offset:64
  buffer_load_dword v114, v124, s[12:15], s39 offen
  buffer_load_dword v115, v124, s[12:15], s49 offen
  s_add_u32 m0, s46, 0
  s_nop 0
  buffer_load_dwordx4 v119, s[20:23], s35 offen  lds
  s_add_u32 m0, s46, 8192
  s_nop 0
  buffer_load_dwordx4 v119, s[24:27], s35 offen  lds
  s_add_u32 s35, s35, 57344
  s_add_u32 m0, s46, 1024
  s_nop 0
  buffer_load_dwordx4 v120, s[20:23], s35 offen  lds
  s_add_u32 m0, s46, 9216
  s_nop 0
  buffer_load_dwordx4 v120, s[24:27], s35 offen  lds
  s_add_u32 s35, s35, 57344
  s_add_u32 m0, s46, 2048
  s_nop 0
  buffer_load_dwordx4 v119, s[20:23], s35 offen  lds
  s_add_u32 m0, s46, 10240
  s_nop 0
  buffer_load_dwordx4 v119, s[24:27], s35 offen  lds
  s_add_u32 s35, s35, 57344
  s_add_u32 m0, s46, 3072
  s_nop 0
  buffer_load_dwordx4 v120, s[20:23], s35 offen  lds
  s_add_u32 m0, s46, 11264
  s_nop 0
  buffer_load_dwordx4 v120, s[24:27], s35 offen  lds
  s_add_u32 s35, s35, 57344
  s_add_u32 m0, s46, 4096
  s_nop 0
  buffer_load_dwordx4 v119, s[20:23], s35 offen  lds
  s_add_u32 m0, s46, 12288
  s_nop 0
  buffer_load_dwordx4 v119, s[24:27], s35 offen  lds
  s_add_u32 s35, s35, 57344
  s_add_u32 m0, s46, 5120
  s_nop 0
  buffer_load_dwordx4 v120, s[20:23], s35 offen  lds
  s_add_u32 m0, s46, 13312
  s_nop 0
  buffer_load_dwordx4 v120, s[24:27], s35 offen  lds
  s_add_u32 s35, s35, 57344
  s_add_u32 m0, s46, 6144
  s_nop 0
  buffer_load_dwordx4 v119, s[20:23], s35 offen  lds
  s_add_u32 m0, s46, 14336
  s_nop 0
  buffer_load_dwordx4 v119, s[24:27], s35 offen  lds
  s_add_u32 s35, s35, 57344
  s_add_u32 m0, s46, 7168
  s_nop 0
  buffer_load_dwordx4 v120, s[20:23], s35 offen  lds
  s_add_u32 m0, s46, 15360
  s_nop 0
  buffer_load_dwordx4 v120, s[24:27], s35 offen  lds
  s_mov_b32 s30, 7340032
  s_mov_b32 s31, 0x20000
  v_lshrrev_b32 v120, 4, v2
  v_lshlrev_b32 v121, 4, v120
  s_lshl_b32 s38, s37, 9
  s_lshl_b32 s39, s3, 7
  s_add_u32 s38, s38, s39
  v_add_u32 v121, s38, v121
  v_bfe_u32 v122, v2, 2, 2
  v_lshl_add_u32 v122, v120, 3, v122
  v_lshlrev_b32 v122, 7, v122
  v_and_b32 v123, 3, v2
  v_lshl_add_u32 v122, v123, 3, v122
  v_add_u32 v122, s46, v122
  v_bfe_u32 v123, v2, 3, 2
  v_lshlrev_b32 v123, 5, v123
  v_add_u32 v108, v122, v123
  v_xor_b32 v118, 32, v123
  v_add_u32 v109, v122, v118
  v_xor_b32 v118, 64, v123
  v_add_u32 v110, v122, v118
  v_xor_b32 v118, 0x60, v123
  v_add_u32 v111, v122, v118
  s_lshl_b32 s48, s34, 15
  v_lshlrev_b32 v116, 3, v0
  v_lshlrev_b32 v121, 4, v120
  s_waitcnt vmcnt(16)
  v_lshlrev_b32 v76, 16, v68
  v_and_b32 v77, 0xffff0000, v68
  v_lshlrev_b32 v78, 16, v69
  v_and_b32 v79, 0xffff0000, v69
  v_lshlrev_b32 v80, 16, v70
  v_and_b32 v81, 0xffff0000, v70
  v_lshlrev_b32 v82, 16, v71
  v_and_b32 v83, 0xffff0000, v71
  v_lshlrev_b32 v84, 16, v72
  v_and_b32 v85, 0xffff0000, v72
  v_lshlrev_b32 v86, 16, v73
  v_and_b32 v87, 0xffff0000, v73
  v_lshlrev_b32 v88, 16, v74
  v_and_b32 v89, 0xffff0000, v74
  v_lshlrev_b32 v90, 16, v75
  v_and_b32 v91, 0xffff0000, v75
  v_add_f32 v76, v76, v114
  v_add_f32 v77, v77, v114
  v_add_f32 v78, v78, v114
  v_add_f32 v79, v79, v114
  v_add_f32 v80, v80, v114
  v_add_f32 v81, v81, v114
  v_add_f32 v82, v82, v114
  v_add_f32 v83, v83, v114
  v_add_f32 v84, v84, v114
  v_add_f32 v85, v85, v114
  v_add_f32 v86, v86, v114
  v_add_f32 v87, v87, v114
  v_add_f32 v88, v88, v114
  v_add_f32 v89, v89, v114
  v_add_f32 v90, v90, v114
  v_add_f32 v91, v91, v114
  v_cvt_pk_bf16_f32 v100, v76, v77
  v_cvt_pk_bf16_f32 v101, v78, v79
  v_cvt_pk_bf16_f32 v102, v80, v81
  v_cvt_pk_bf16_f32 v103, v82, v83
  v_cvt_pk_bf16_f32 v104, v84, v85
  v_cvt_pk_bf16_f32 v105, v86, v87
  v_cvt_pk_bf16_f32 v106, v88, v89
  v_cvt_pk_bf16_f32 v107, v90, v91
  v_lshlrev_b32 v76, 16, v100
  v_and_b32 v77, 0xffff0000, v100
  v_lshlrev_b32 v78, 16, v101
  v_and_b32 v79, 0xffff0000, v101
  v_lshlrev_b32 v80, 16, v102
  v_and_b32 v81, 0xffff0000, v102
  v_lshlrev_b32 v82, 16, v103
  v_and_b32 v83, 0xffff0000, v103
  v_lshlrev_b32 v84, 16, v104
  v_and_b32 v85, 0xffff0000, v104
  v_lshlrev_b32 v86, 16, v105
  v_and_b32 v87, 0xffff0000, v105
  v_lshlrev_b32 v88, 16, v106
  v_and_b32 v89, 0xffff0000, v106
  v_lshlrev_b32 v90, 16, v107
  v_and_b32 v91, 0xffff0000, v107
  v_mul_f32 v76, v76, v115
  v_mul_f32 v77, v77, v115
  v_mul_f32 v78, v78, v115
  v_mul_f32 v79, v79, v115
  v_mul_f32 v80, v80, v115
  v_mul_f32 v81, v81, v115
  v_mul_f32 v82, v82, v115
  v_mul_f32 v83, v83, v115
  v_mul_f32 v84, v84, v115
  v_mul_f32 v85, v85, v115
  v_mul_f32 v86, v86, v115
  v_mul_f32 v87, v87, v115
  v_mul_f32 v88, v88, v115
  v_mul_f32 v89, v89, v115
  v_mul_f32 v90, v90, v115
  v_mul_f32 v91, v91, v115
  v_cvt_pk_bf16_f32 v100, v76, v77
  v_cvt_pk_bf16_f32 v101, v78, v79
  v_cvt_pk_bf16_f32 v102, v80, v81
  v_cvt_pk_bf16_f32 v103, v82, v83
  v_cvt_pk_bf16_f32 v104, v84, v85
  v_cvt_pk_bf16_f32 v105, v86, v87
  v_cvt_pk_bf16_f32 v106, v88, v89
  v_cvt_pk_bf16_f32 v107, v90, v91
  s_cmp_lg_u32 s36, 0
  s_cbranch_scc1 K2_NOPUB
  s_add_u32 s38, s40, 8388608
  s_add_u32 s39, s38, 4096
  s_mov_b32 s42, 0x00010001
  s_mov_b32 s43, 0x00010001
  s_mov_b64 exec, s[42:43]
  buffer_store_dwordx4 v[68:71], v121, s[12:15], s38 offen offset:2048 sc1
  buffer_store_dwordx4 v[72:75], v121, s[12:15], s38 offen offset:2112 sc1
  buffer_store_dwordx4 v[100:103], v121, s[12:15], s39 offen sc1
  buffer_store_dwordx4 v[104:107], v121, s[12:15], s39 offen offset:64 sc1
  s_mov_b32 s38, 8394752
  v_mov_b32 v112, s50
  buffer_store_dword v112, v124, s[12:15], s38 offen sc1
  s_mov_b64 exec, -1
K2_NOPUB:
  s_setprio 3
  s_waitcnt vmcnt(0)
  ds_read_b64_tr_b16 v[4:5], v108 offset:0
  ds_read_b64_tr_b16 v[6:7], v108 offset:512
  ds_read_b64_tr_b16 v[8:9], v108 offset:4096
  ds_read_b64_tr_b16 v[10:11], v108 offset:4608
  ds_read_b64_tr_b16 v[12:13], v109 offset:0
  ds_read_b64_tr_b16 v[14:15], v109 offset:512
  ds_read_b64_tr_b16 v[16:17], v109 offset:4096
  ds_read_b64_tr_b16 v[18:19], v109 offset:4608
  ds_read_b64_tr_b16 v[20:21], v110 offset:0
  ds_read_b64_tr_b16 v[22:23], v110 offset:512
  ds_read_b64_tr_b16 v[24:25], v110 offset:4096
  ds_read_b64_tr_b16 v[26:27], v110 offset:4608
  ds_read_b64_tr_b16 v[28:29], v111 offset:0
  ds_read_b64_tr_b16 v[30:31], v111 offset:512
  ds_read_b64_tr_b16 v[32:33], v111 offset:4096
  ds_read_b64_tr_b16 v[34:35], v111 offset:4608
  ds_read_b64_tr_b16 v[36:37], v108 offset:8192
  ds_read_b64_tr_b16 v[38:39], v108 offset:8704
  ds_read_b64_tr_b16 v[40:41], v108 offset:12288
  ds_read_b64_tr_b16 v[42:43], v108 offset:12800
  ds_read_b64_tr_b16 v[44:45], v109 offset:8192
  ds_read_b64_tr_b16 v[46:47], v109 offset:8704
  ds_read_b64_tr_b16 v[48:49], v109 offset:12288
  ds_read_b64_tr_b16 v[50:51], v109 offset:12800
  ds_read_b64_tr_b16 v[52:53], v110 offset:8192
  ds_read_b64_tr_b16 v[54:55], v110 offset:8704
  ds_read_b64_tr_b16 v[56:57], v110 offset:12288
  ds_read_b64_tr_b16 v[58:59], v110 offset:12800
  ds_read_b64_tr_b16 v[60:61], v111 offset:8192
  ds_read_b64_tr_b16 v[62:63], v111 offset:8704
  ds_read_b64_tr_b16 v[64:65], v111 offset:12288
  ds_read_b64_tr_b16 v[66:67], v111 offset:12800
  buffer_load_dwordx2 v[68:69], v116, s[28:31], s48 offen offset:0
  buffer_load_dwordx2 v[70:71], v116, s[28:31], s48 offen offset:2048
  s_add_u32 s48, s48, 4096
  buffer_load_dwordx2 v[72:73], v116, s[28:31], s48 offen offset:0
  buffer_load_dwordx2 v[74:75], v116, s[28:31], s48 offen offset:2048
  s_add_u32 s48, s48, 4096
  buffer_load_dwordx2 v[76:77], v116, s[28:31], s48 offen offset:0
  buffer_load_dwordx2 v[78:79], v116, s[28:31], s48 offen offset:2048
  s_add_u32 s48, s48, 4096
  buffer_load_dwordx2 v[80:81], v116, s[28:31], s48 offen offset:0
  buffer_load_dwordx2 v[82:83], v116, s[28:31], s48 offen offset:2048
  s_add_u32 s48, s48, 4096
  buffer_load_dwordx2 v[84:85], v116, s[28:31], s48 offen offset:0
  buffer_load_dwordx2 v[86:87], v116, s[28:31], s48 offen offset:2048
  s_add_u32 s48, s48, 4096
  buffer_load_dwordx2 v[88:89], v116, s[28:31], s48 offen offset:0
  buffer_load_dwordx2 v[90:91], v116, s[28:31], s48 offen offset:2048
  s_add_u32 s48, s48, 4096
  buffer_load_dwordx2 v[92:93], v116, s[28:31], s48 offen offset:0
  buffer_load_dwordx2 v[94:95], v116, s[28:31], s48 offen offset:2048
  s_add_u32 s48, s48, 4096
  buffer_load_dwordx2 v[96:97], v116, s[28:31], s48 offen offset:0
  buffer_load_dwordx2 v[98:99], v116, s[28:31], s48 offen offset:2048
  s_waitcnt lgkmcnt(0)
  v_mfma_f32_16x16x32_bf16 v[128:131], v[100:103], v[4:7], 0
  v_mfma_f32_16x16x32_bf16 v[132:135], v[100:103], v[12:15], 0
  v_mfma_f32_16x16x32_bf16 v[136:139], v[100:103], v[20:23], 0
  v_mfma_f32_16x16x32_bf16 v[140:143], v[100:103], v[28:31], 0
  v_mfma_f32_16x16x32_bf16 v[144:147], v[100:103], v[36:39], 0
  v_mfma_f32_16x16x32_bf16 v[148:151], v[100:103], v[44:47], 0
  v_mfma_f32_16x16x32_bf16 v[152:155], v[100:103], v[52:55], 0
  v_mfma_f32_16x16x32_bf16 v[156:159], v[100:103], v[60:63], 0
  v_mfma_f32_16x16x32_bf16 v[128:131], v[104:107], v[8:11], v[128:131]
  v_mfma_f32_16x16x32_bf16 v[132:135], v[104:107], v[16:19], v[132:135]
  v_mfma_f32_16x16x32_bf16 v[136:139], v[104:107], v[24:27], v[136:139]
  v_mfma_f32_16x16x32_bf16 v[140:143], v[104:107], v[32:35], v[140:143]
  v_mfma_f32_16x16x32_bf16 v[144:147], v[104:107], v[40:43], v[144:147]
  v_mfma_f32_16x16x32_bf16 v[148:151], v[104:107], v[48:51], v[148:151]
  v_mfma_f32_16x16x32_bf16 v[152:155], v[104:107], v[56:59], v[152:155]
  v_mfma_f32_16x16x32_bf16 v[156:159], v[104:107], v[64:67], v[156:159]
  s_lshl_b32 s38, s3, 9
  v_lshlrev_b32 v117, 2, v2
  v_add_u32 v117, s38, v117
  s_mov_b64 exec, 0xffff
  ds_write_b32 v117, v128 offset:3072
  ds_write_b32 v117, v132 offset:3136
  ds_write_b32 v117, v136 offset:3200
  ds_write_b32 v117, v140 offset:3264
  ds_write_b32 v117, v144 offset:3328
  ds_write_b32 v117, v148 offset:3392
  ds_write_b32 v117, v152 offset:3456
  ds_write_b32 v117, v156 offset:3520
  s_mov_b64 exec, -1
  s_mov_b64 exec, 1
  ds_add_u32 v124, v125 offset:4
  s_mov_b64 exec, -1
  v_and_b32 v117, 15, v2
  v_lshlrev_b32 v117, 2, v117
  s_cmp_lg_u32 s3, 0
  s_cbranch_scc1 K2_WAITH
  v_lshlrev_b32 v118, 3, v2
K2_SPINF:
  ds_read_b32 v120, v124 offset:4
  s_waitcnt lgkmcnt(0)
  v_readfirstlane_b32 s38, v120
  s_nop 1
  s_cmp_lt_u32 s38, 4
  s_cbranch_scc1 K2_SPINF
  ds_read_b64 v[4:5], v118 offset:3072
  ds_read_b64 v[6:7], v118 offset:3584
  ds_read_b64 v[8:9], v118 offset:4096
  ds_read_b64 v[10:11], v118 offset:4608
  s_lshl_b32 s38, s34, 10
  s_add_u32 s38, s38, 8454144
  v_lshlrev_b32 v120, 4, v2
  v_mov_b32 v13, 0x5eed1e55
  v_mov_b32 v15, 0x5eed1e55
  v_lshrrev_b32 v122, 4, v2
  v_lshlrev_b32 v122, 10, v122
  v_lshl_add_u32 v122, v117, 1, v122
  s_lshl_b32 s39, s36, 12
  s_lshl_b32 s49, s37, 7
  s_add_u32 s39, s39, s49
  s_add_u32 s39, s39, 8454144
  s_waitcnt lgkmcnt(0)
  v_add_f32 v4, v4, v6
  v_add_f32 v5, v5, v7
  v_add_f32 v8, v8, v10
  v_add_f32 v9, v9, v11
  v_add_f32 v12, v4, v8
  v_add_f32 v14, v5, v9
  buffer_store_dwordx4 v[12:15], v120, s[12:15], s38 offen sc1
  s_mov_b32 s49, 0
K2_POLL:
  buffer_load_dwordx2 v[4:5], v122, s[12:15], s39 offen sc1
  buffer_load_dwordx2 v[8:9], v122, s[12:15], s39 offen offset:512 sc1
  s_add_u32 s49, s49, 1
  s_waitcnt vmcnt(0)
  v_and_b32 v6, v5, v9
  v_cmp_ne_u32 vcc, 0x5eed1e55, v6
  s_cmp_gt_u32 s49, 100000
  s_cbranch_scc1 K2_POLLED
  s_nop 4
  s_cbranch_vccnz K2_POLL
K2_POLLED:
  v_mov_b32 v5, v4
  v_mov_b32 v9, v8
  s_nop 0
  v_permlane32_swap_b32 v4, v5
  v_permlane32_swap_b32 v8, v9
  v_add_f32 v4, v4, v5
  v_add_f32 v8, v8, v9
  v_mov_b32 v5, v4
  v_mov_b32 v9, v8
  s_nop 0
  v_permlane16_swap_b32 v4, v5
  v_permlane16_swap_b32 v8, v9
  v_add_f32 v4, v4, v5
  v_add_f32 v8, v8, v9
  v_cvt_pk_bf16_f32 v5, v4, v8
  v_lshlrev_b32 v4, 16, v5
  v_and_b32 v8, 0xffff0000, v5
  v_mul_f32 v6, 0xbfb8aa3b, v4
  v_exp_f32 v6, v6
  s_nop 0
  v_add_f32 v6, 1.0, v6
  v_rcp_f32 v6, v6
  s_nop 0
  v_mul_f32 v6, v4, v6
  v_cvt_pk_bf16_f32 v6, v6, v6
  v_lshlrev_b32 v6, 16, v6
  v_mul_f32 v6, v6, v8
  v_cvt_pk_bf16_f32 v6, v6, v6
  v_and_b32 v6, 0xffff, v6
  s_mov_b64 exec, 0xffff
  ds_write_b32 v117, v6 offset:64
  s_mov_b64 exec, -1
  s_mov_b64 exec, 1
  ds_add_u32 v124, v125 offset:16
  s_mov_b64 exec, -1
K2_WAITH:
  s_sleep 1
  ds_read_b32 v120, v124 offset:16
  s_waitcnt lgkmcnt(0)
  v_readfirstlane_b32 s38, v120
  s_nop 1
  s_cmp_lt_u32 s38, 1
  s_cbranch_scc1 K2_WAITH
  ds_read_b32 v6, v117 offset:64
  s_waitcnt lgkmcnt(0)
  v_readlane_b32 s40, v6, 0
  v_readlane_b32 s41, v6, 1
  v_readlane_b32 s42, v6, 2
  v_readlane_b32 s43, v6, 3
  v_readlane_b32 s44, v6, 4
  v_readlane_b32 s45, v6, 5
  v_readlane_b32 s46, v6, 6
  v_readlane_b32 s47, v6, 7
  v_readlane_b32 s48, v6, 8
  v_readlane_b32 s49, v6, 9
  v_readlane_b32 s50, v6, 10
  v_readlane_b32 s51, v6, 11
  v_readlane_b32 s52, v6, 12
  v_readlane_b32 s53, v6, 13
  v_readlane_b32 s54, v6, 14
  v_readlane_b32 s55, v6, 15
  s_lshl_b32 s64, s40, 16
  s_lshl_b32 s65, s41, 16
  s_lshl_b32 s66, s42, 16
  s_lshl_b32 s67, s43, 16
  s_lshl_b32 s68, s44, 16
  s_lshl_b32 s69, s45, 16
  s_lshl_b32 s70, s46, 16
  s_lshl_b32 s71, s47, 16
  s_lshl_b32 s72, s48, 16
  s_lshl_b32 s73, s49, 16
  s_lshl_b32 s74, s50, 16
  s_lshl_b32 s75, s51, 16
  s_lshl_b32 s76, s52, 16
  s_lshl_b32 s77, s53, 16
  s_lshl_b32 s78, s54, 16
  s_lshl_b32 s79, s55, 16
  s_waitcnt vmcnt(0)
  v_dot2_f32_bf16 v12, v68, s40, 0
  v_dot2_f32_bf16 v13, v68, s64, 0
  v_dot2_f32_bf16 v14, v69, s40, 0
  v_dot2_f32_bf16 v15, v69, s64, 0
  v_dot2_f32_bf16 v12, v70, s41, v12
  v_dot2_f32_bf16 v13, v70, s65, v13
  v_dot2_f32_bf16 v14, v71, s41, v14
  v_dot2_f32_bf16 v15, v71, s65, v15
  v_dot2_f32_bf16 v12, v72, s42, v12
  v_dot2_f32_bf16 v13, v72, s66, v13
  v_dot2_f32_bf16 v14, v73, s42, v14
  v_dot2_f32_bf16 v15, v73, s66, v15
  v_dot2_f32_bf16 v12, v74, s43, v12
  v_dot2_f32_bf16 v13, v74, s67, v13
  v_dot2_f32_bf16 v14, v75, s43, v14
  v_dot2_f32_bf16 v15, v75, s67, v15
  v_dot2_f32_bf16 v12, v76, s44, v12
  v_dot2_f32_bf16 v13, v76, s68, v13
  v_dot2_f32_bf16 v14, v77, s44, v14
  v_dot2_f32_bf16 v15, v77, s68, v15
  v_dot2_f32_bf16 v12, v78, s45, v12
  v_dot2_f32_bf16 v13, v78, s69, v13
  v_dot2_f32_bf16 v14, v79, s45, v14
  v_dot2_f32_bf16 v15, v79, s69, v15
  v_dot2_f32_bf16 v12, v80, s46, v12
  v_dot2_f32_bf16 v13, v80, s70, v13
  v_dot2_f32_bf16 v14, v81, s46, v14
  v_dot2_f32_bf16 v15, v81, s70, v15
  v_dot2_f32_bf16 v12, v82, s47, v12
  v_dot2_f32_bf16 v13, v82, s71, v13
  v_dot2_f32_bf16 v14, v83, s47, v14
  v_dot2_f32_bf16 v15, v83, s71, v15
  v_dot2_f32_bf16 v12, v84, s48, v12
  v_dot2_f32_bf16 v13, v84, s72, v13
  v_dot2_f32_bf16 v14, v85, s48, v14
  v_dot2_f32_bf16 v15, v85, s72, v15
  v_dot2_f32_bf16 v12, v86, s49, v12
  v_dot2_f32_bf16 v13, v86, s73, v13
  v_dot2_f32_bf16 v14, v87, s49, v14
  v_dot2_f32_bf16 v15, v87, s73, v15
  v_dot2_f32_bf16 v12, v88, s50, v12
  v_dot2_f32_bf16 v13, v88, s74, v13
  v_dot2_f32_bf16 v14, v89, s50, v14
  v_dot2_f32_bf16 v15, v89, s74, v15
  v_dot2_f32_bf16 v12, v90, s51, v12
  v_dot2_f32_bf16 v13, v90, s75, v13
  v_dot2_f32_bf16 v14, v91, s51, v14
  v_dot2_f32_bf16 v15, v91, s75, v15
  v_dot2_f32_bf16 v12, v92, s52, v12
  v_dot2_f32_bf16 v13, v92, s76, v13
  v_dot2_f32_bf16 v14, v93, s52, v14
  v_dot2_f32_bf16 v15, v93, s76, v15
  v_dot2_f32_bf16 v12, v94, s53, v12
  v_dot2_f32_bf16 v13, v94, s77, v13
  v_dot2_f32_bf16 v14, v95, s53, v14
  v_dot2_f32_bf16 v15, v95, s77, v15
  v_dot2_f32_bf16 v12, v96, s54, v12
  v_dot2_f32_bf16 v13, v96, s78, v13
  v_dot2_f32_bf16 v14, v97, s54, v14
  v_dot2_f32_bf16 v15, v97, s78, v15
  v_dot2_f32_bf16 v12, v98, s55, v12
  v_dot2_f32_bf16 v13, v98, s79, v13
  v_dot2_f32_bf16 v14, v99, s55, v14
  v_dot2_f32_bf16 v15, v99, s79, v15
  s_lshl_b32 s38, s34, 12
  s_add_u32 s38, s38, 7340032
  v_lshlrev_b32 v116, 4, v0
  buffer_store_dwordx4 v[12:15], v116, s[12:15], s38 offen sc1
K2_GATHER:
K2_END:
  s_endpgm
.p2align 6
K2_CONST:
.long 0x0, 0x0, 0x0, 0x0
.long 0x0, 0x0, 0x0, 0x0
.long 0x0, 0x0, 0x0, 0x0
.long 0x0, 0x0, 0x0, 0x0
.long 0x0, 0x0, 0x0, 0x0
.long 0x0, 0x0, 0x0, 0x0
.long 0x0, 0x0, 0x0, 0x0
.long 0x0, 0x0, 0x0, 0x0
.long 0x0, 0x0, 0x0, 0x0
.long 0x0, 0x0, 0x0, 0x0
.long 0x0, 0x0, 0x0, 0x0
.long 0x0, 0x0, 0x0, 0x0
.long 0x0, 0x0, 0x0, 0x0
.long 0x0, 0x0, 0x0, 0x0
.long 0x0, 0x0, 0x0, 0x0
.long 0x0, 0x0, 0x0, 0x0
.long 0x0, 0x3c000000, 0x3c003c00, 0x0
.long 0x0, 0x0, 0x3c003c00, 0x3c00
.long 0x0, 0x0, 0x3c000000, 0x3c003c00
.long 0x0, 0x0, 0x0, 0x3c003c00
.long 0x0, 0x0, 0x0, 0x3c000000
.long 0x0, 0x0, 0x0, 0x0
.long 0x0, 0x0, 0x0, 0x0
.long 0x0, 0x0, 0x0, 0x0
.long 0x0, 0x0, 0x0, 0x0
.long 0x0, 0x0, 0x0, 0x0
.long 0x0, 0x0, 0x0, 0x0
.long 0x0, 0x0, 0x0, 0x0
.long 0x0, 0x0, 0x0, 0x0
.long 0x0, 0x0, 0x0, 0x0
.long 0x0, 0x0, 0x0, 0x0
.long 0x0, 0x0, 0x0, 0x0
.long 0x0, 0x0, 0x0, 0x0
.long 0x0, 0x0, 0x0, 0x0
.long 0x0, 0x0, 0x0, 0x0
.long 0x3c00, 0x0, 0x0, 0x0
.long 0x3c003c00, 0x0, 0x0, 0x0
.long 0x3c003c00, 0x3c00, 0x0, 0x0
.long 0x3c000000, 0x3c003c00, 0x0, 0x0
.long 0x0, 0x3c003c00, 0x3c00, 0x0
.long 0x0, 0x3c000000, 0x3c003c00, 0x0
.long 0x0, 0x0, 0x3c003c00, 0x3c00
.long 0x0, 0x0, 0x3c000000, 0x3c003c00
.long 0x0, 0x0, 0x0, 0x3c003c00
.long 0x0, 0x0, 0x0, 0x3c000000
.long 0x0, 0x0, 0x0, 0x0
.long 0x0, 0x0, 0x0, 0x0
.long 0x0, 0x0, 0x0, 0x0
.long 0x0, 0x0, 0x0, 0x0
.long 0x0, 0x0, 0x0, 0x0
.long 0x0, 0x0, 0x0, 0x0
.long 0x0, 0x0, 0x0, 0x0
.long 0x0, 0x0, 0x0, 0x0
.long 0x0, 0x0, 0x0, 0x0
.long 0x0, 0x0, 0x0, 0x0
.long 0x0, 0x0, 0x0, 0x0
.long 0x0, 0x0, 0x0, 0x0
.long 0x0, 0x0, 0x0, 0x0
.long 0x0, 0x0, 0x0, 0x0
.long 0x3c00, 0x0, 0x0, 0x0
.long 0x3c003c00, 0x0, 0x0, 0x0
.long 0x3c003c00, 0x3c00, 0x0, 0x0
.long 0x3c000000, 0x3c003c00, 0x0, 0x0
.long 0x0, 0x3c003c00, 0x3c00, 0x0
.long 0x0, 0x0, 0x0, 0x3c003c00
.long 0x0, 0x0, 0x0, 0x3c000000
.long 0x0, 0x0, 0x0, 0x0
.long 0x0, 0x0, 0x0, 0x0
.long 0x0, 0x0, 0x0, 0x0
.long 0x0, 0x0, 0x0, 0x0
.long 0x0, 0x0, 0x0, 0x0
.long 0x0, 0x0, 0x0, 0x0
.long 0x0, 0x0, 0x0, 0x0
.long 0x0, 0x0, 0x0, 0x0
.long 0x0, 0x0, 0x0, 0x0
.long 0x0, 0x0, 0x0, 0x0
.long 0x0, 0x0, 0x0, 0x0
.long 0x0, 0x0, 0x0, 0x0
.long 0x0, 0x0, 0x0, 0x0
.long 0x0, 0x0, 0x0, 0x0
.long 0x3c003c00, 0x3c00, 0x0, 0x0
.long 0x3c003c00, 0x3c003c00, 0x0, 0x0
.long 0x3c003c00, 0x3c003c00, 0x3c00, 0x0
.long 0x3c000000, 0x3c003c00, 0x3c003c00, 0x0
.long 0x0, 0x3c003c00, 0x3c003c00, 0x3c00
.long 0x0, 0x3c000000, 0x3c003c00, 0x3c003c00
.long 0x0, 0x0, 0x3c003c00, 0x3c003c00
.long 0x0, 0x0, 0x3c000000, 0x3c003c00
.long 0x0, 0x0, 0x0, 0x3c003c00
.long 0x0, 0x0, 0x0, 0x3c000000
.long 0x0, 0x0, 0x0, 0x0
.long 0x0, 0x0, 0x0, 0x0
.long 0x0, 0x0, 0x0, 0x0
.long 0x0, 0x0, 0x0, 0x0
.long 0x0, 0x0, 0x0, 0x0
.long 0x0, 0x0, 0x0, 0x0
.long 0x0, 0x0, 0x0, 0x0
.long 0x0, 0x0, 0x0, 0x0
.long 0x0, 0x0, 0x0, 0x0
.long 0x0, 0x0, 0x0, 0x0
.long 0x0, 0x0, 0x0, 0x0
.long 0x0, 0x0, 0x0, 0x0
.long 0x3c00, 0x0, 0x0, 0x0
.long 0x3c003c00, 0x0, 0x0, 0x0
.long 0x3c003c00, 0x3c00, 0x0, 0x0
.long 0x3c003c00, 0x3c003c00, 0x0, 0x0
.long 0x3c003c00, 0x3c003c00, 0x3c00, 0x0
.long 0x3c000000, 0x3c003c00, 0x3c003c00, 0x0
.long 0x0, 0x3c003c00, 0x3c003c00, 0x3c00
.long 0x0, 0x3c000000, 0x3c003c00, 0x3c003c00
.long 0x0, 0x0, 0x3c003c00, 0x3c003c00
.long 0x0, 0x0, 0x3c000000, 0x3c003c00
.long 0x0, 0x0, 0x0, 0x0
.long 0x0, 0x0, 0x0, 0x0
.long 0x0, 0x0, 0x0, 0x0
.long 0x0, 0x0, 0x0, 0x0
.long 0x0, 0x0, 0x0, 0x0
.long 0x0, 0x0, 0x0, 0x0
.long 0x0, 0x0, 0x0, 0x0
.long 0x0, 0x0, 0x0, 0x0
.long 0x0, 0x0, 0x0, 0x0
.long 0x0, 0x0, 0x0, 0x0
.long 0x0, 0x0, 0x0, 0x0
.long 0x0, 0x0, 0x0, 0x0
.long 0x0, 0x0, 0x0, 0x0
.long 0x0, 0x0, 0x0, 0x0
.long 0x3c00, 0x0, 0x0, 0x0
.long 0x3c003c00, 0x0, 0x0, 0x0
.long 0x0, 0x3c000000, 0x3c003c00, 0x0
.long 0x0, 0x0, 0x3c003c00, 0x3c00
.long 0x0, 0x0, 0x3c000000, 0x3c003c00
.long 0x0, 0x0, 0x0, 0x3c003c00
.long 0x0, 0x0, 0x0, 0x3c000000
.long 0x0, 0x0, 0x0, 0x0
.long 0x0, 0x0, 0x0, 0x0
.long 0x0, 0x0, 0x0, 0x0
.long 0x0, 0x0, 0x0, 0x0
.long 0x0, 0x0, 0x0, 0x0
.long 0x0, 0x0, 0x0, 0x0
.long 0x0, 0x0, 0x0, 0x0
.long 0x0, 0x0, 0x0, 0x0
.long 0x0, 0x0, 0x0, 0x0
.long 0x0, 0x0, 0x0, 0x0
.long 0x0, 0x0, 0x0, 0x0
.long 0x0, 0x0, 0x0, 0x0
.long 0x0, 0x0, 0x0, 0x0
.long 0x0, 0x0, 0x0, 0x0
.long 0x3c00, 0x0, 0x0, 0x0
.long 0x3c003c00, 0x0, 0x0, 0x0
.long 0x3c003c00, 0x3c00, 0x0, 0x0
.long 0x3c000000, 0x3c003c00, 0x0, 0x0
.long 0x0, 0x3c003c00, 0x3c00, 0x0
.long 0x0, 0x3c000000, 0x3c003c00, 0x0
.long 0x0, 0x0, 0x3c003c00, 0x3c00
.long 0x0, 0x0, 0x3c000000, 0x3c003c00
.long 0x0, 0x0, 0x0, 0x3c003c00
.long 0x0, 0x0, 0x0, 0x3c000000
.long 0x0, 0x0, 0x0, 0x0
.long 0x0, 0x0, 0x0, 0x0
.long 0x0, 0x0, 0x0, 0x0
.long 0x0, 0x0, 0x0, 0x0
.long 0x0, 0x0, 0x0, 0x0
.long 0x0, 0x0, 0x0, 0x0
.long 0x0, 0x0, 0x0, 0x0
.long 0x0, 0x0, 0x0, 0x0
.long 0x0, 0x0, 0x0, 0x0
.long 0x0, 0x0, 0x0, 0x0
.long 0x0, 0x0, 0x0, 0x0
.long 0x0, 0x0, 0x0, 0x0
.long 0x0, 0x0, 0x0, 0x0
.long 0x0, 0x0, 0x0, 0x0
.long 0x3c00, 0x0, 0x0, 0x0
.long 0x3c003c00, 0x0, 0x0, 0x0
.long 0x3c003c00, 0x3c00, 0x0, 0x0
.long 0x3c000000, 0x3c003c00, 0x0, 0x0
.long 0x0, 0x3c003c00, 0x3c00, 0x0
.long 0x0, 0x0, 0x0, 0x0
.long 0x0, 0x0, 0x0, 0x0
.long 0x0, 0x0, 0x0, 0x0
.long 0x0, 0x0, 0x0, 0x0
.long 0x0, 0x0, 0x0, 0x0
.long 0x0, 0x0, 0x0, 0x0
.long 0x0, 0x0, 0x0, 0x0
.long 0x0, 0x0, 0x0, 0x0
.long 0x0, 0x0, 0x0, 0x0
.long 0x0, 0x0, 0x0, 0x0
.long 0x0, 0x0, 0x0, 0x0
.long 0x0, 0x0, 0x0, 0x0
.long 0x0, 0x0, 0x0, 0x0
.long 0x0, 0x0, 0x0, 0x0
.long 0x0, 0x0, 0x0, 0x0
.long 0x0, 0x0, 0x0, 0x0
.long 0x0, 0x0, 0x0, 0x3c003c00
.long 0x0, 0x0, 0x0, 0x3c000000
.long 0x0, 0x0, 0x0, 0x0
.long 0x0, 0x0, 0x0, 0x0
.long 0x0, 0x0, 0x0, 0x0
.long 0x0, 0x0, 0x0, 0x0
.long 0x0, 0x0, 0x0, 0x0
.long 0x0, 0x0, 0x0, 0x0
.long 0x0, 0x0, 0x0, 0x0
.long 0x0, 0x0, 0x0, 0x0
.long 0x0, 0x0, 0x0, 0x0
.long 0x0, 0x0, 0x0, 0x0
.long 0x0, 0x0, 0x0, 0x0
.long 0x0, 0x0, 0x0, 0x0
.long 0x0, 0x0, 0x0, 0x0
.long 0x0, 0x0, 0x0, 0x0
.long 0x3c003c00, 0x3c00, 0x0, 0x0
.long 0x3c003c00, 0x3c003c00, 0x0, 0x0
.long 0x3c003c00, 0x3c003c00, 0x3c00, 0x0
.long 0x3c000000, 0x3c003c00, 0x3c003c00, 0x0
.long 0x0, 0x3c003c00, 0x3c003c00, 0x3c00
.long 0x0, 0x3c000000, 0x3c003c00, 0x3c003c00
.long 0x0, 0x0, 0x3c003c00, 0x3c003c00
.long 0x0, 0x0, 0x3c000000, 0x3c003c00
.long 0x0, 0x0, 0x0, 0x3c003c00
.long 0x0, 0x0, 0x0, 0x3c000000
.long 0x0, 0x0, 0x0, 0x0
.long 0x0, 0x0, 0x0, 0x0
.long 0x0, 0x0, 0x0, 0x0
.long 0x0, 0x0, 0x0, 0x0
.long 0x0, 0x0, 0x0, 0x0
.long 0x0, 0x0, 0x0, 0x0
.long 0x0, 0x0, 0x0, 0x0
.long 0x0, 0x0, 0x0, 0x0
.long 0x0, 0x0, 0x0, 0x0
.long 0x0, 0x0, 0x0, 0x0
.long 0x0, 0x0, 0x0, 0x0
.long 0x0, 0x0, 0x0, 0x0
.long 0x3c00, 0x0, 0x0, 0x0
.long 0x3c003c00, 0x0, 0x0, 0x0
.long 0x3c003c00, 0x3c00, 0x0, 0x0
.long 0x3c003c00, 0x3c003c00, 0x0, 0x0
.long 0x3c003c00, 0x3c003c00, 0x3c00, 0x0
.long 0x3c000000, 0x3c003c00, 0x3c003c00, 0x0
.long 0x0, 0x3c003c00, 0x3c003c00, 0x3c00
.long 0x0, 0x3c000000, 0x3c003c00, 0x3c003c00
.long 0x0, 0x0, 0x3c003c00, 0x3c003c00
.long 0x0, 0x0, 0x3c000000, 0x3c003c00
.long 0x0, 0x0, 0x0, 0x0
.long 0x0, 0x0, 0x0, 0x0
.long 0x0, 0x0, 0x0, 0x0
.long 0x0, 0x0, 0x0, 0x0
.long 0x0, 0x0, 0x0, 0x0
.long 0x0, 0x0, 0x0, 0x0
.long 0x0, 0x0, 0x0, 0x0
.long 0x0, 0x0, 0x0, 0x0
.long 0x0, 0x0, 0x0, 0x0
.long 0x0, 0x0, 0x0, 0x0
.long 0x0, 0x0, 0x0, 0x0
.long 0x0, 0x0, 0x0, 0x0
.long 0x0, 0x0, 0x0, 0x0
.long 0x0, 0x0, 0x0, 0x0
.long 0x3c00, 0x0, 0x0, 0x0
.long 0x3c003c00, 0x0, 0x0, 0x0
.long 0x0, 0x0, 0x3c000000, 0x3c003c00
.long 0x0, 0x0, 0x0, 0x3c003c00
.long 0x0, 0x0, 0x0, 0x3c000000
.long 0x0, 0x0, 0x0, 0x0
.long 0x0, 0x0, 0x0, 0x0
.long 0x0, 0x0, 0x0, 0x0
.long 0x0, 0x0, 0x0, 0x0
.long 0x0, 0x0, 0x0, 0x0
.long 0x0, 0x0, 0x0, 0x0
.long 0x0, 0x0, 0x0, 0x0
.long 0x0, 0x0, 0x0, 0x0
.long 0x0, 0x0, 0x0, 0x0
.long 0x0, 0x0, 0x0, 0x0
.long 0x0, 0x0, 0x0, 0x0
.long 0x0, 0x0, 0x0, 0x0
.long 0x0, 0x0, 0x0, 0x0
.long 0x3c003c00, 0x3c003c00, 0x0, 0x0
.long 0x3c003c00, 0x3c003c00, 0x3c00, 0x0
.long 0x3c003c00, 0x3c003c00, 0x3c003c00, 0x0
.long 0x3c003c00, 0x3c003c00, 0x3c003c00, 0x3c00
.long 0x3c000000, 0x3c003c00, 0x3c003c00, 0x3c003c00
.long 0x0, 0x3c003c00, 0x3c003c00, 0x3c003c00
.long 0x0, 0x3c000000, 0x3c003c00, 0x3c003c00
.long 0x0, 0x0, 0x3c003c00, 0x3c003c00
.long 0x0, 0x0, 0x3c000000, 0x3c003c00
.long 0x0, 0x0, 0x0, 0x3c003c00
.long 0x0, 0x0, 0x0, 0x3c000000
.long 0x0, 0x0, 0x0, 0x0
.long 0x0, 0x0, 0x0, 0x0
.long 0x0, 0x0, 0x0, 0x0
.long 0x0, 0x0, 0x0, 0x0
.long 0x0, 0x0, 0x0, 0x0
.long 0x0, 0x0, 0x0, 0x0
.long 0x0, 0x0, 0x0, 0x0
.long 0x0, 0x0, 0x0, 0x0
.long 0x0, 0x0, 0x0, 0x0
.long 0x0, 0x0, 0x0, 0x0
.long 0x3c00, 0x0, 0x0, 0x0
.long 0x3c003c00, 0x0, 0x0, 0x0
.long 0x3c003c00, 0x3c00, 0x0, 0x0
.long 0x3c003c00, 0x3c003c00, 0x0, 0x0
.long 0x3c003c00, 0x3c003c00, 0x3c00, 0x0
.long 0x3c003c00, 0x3c003c00, 0x3c003c00, 0x0
.long 0x3c003c00, 0x3c003c00, 0x3c003c00, 0x3c00
.long 0x3c000000, 0x3c003c00, 0x3c003c00, 0x3c003c00
.long 0x0, 0x3c003c00, 0x3c003c00, 0x3c003c00
.long 0x0, 0x3c000000, 0x3c003c00, 0x3c003c00
.long 0x0, 0x0, 0x3c003c00, 0x3c003c00
.long 0x0, 0x0, 0x0, 0x0
.long 0x0, 0x0, 0x0, 0x0
.long 0x0, 0x0, 0x0, 0x0
.long 0x0, 0x0, 0x0, 0x0
.long 0x0, 0x0, 0x0, 0x0
.long 0x0, 0x0, 0x0, 0x0
.long 0x0, 0x0, 0x0, 0x0
.long 0x0, 0x0, 0x0, 0x0
.long 0x0, 0x0, 0x0, 0x0
.long 0x0, 0x0, 0x0, 0x0
.long 0x0, 0x0, 0x0, 0x0
.long 0x0, 0x0, 0x0, 0x0
.long 0x0, 0x0, 0x0, 0x0
.long 0x3c00, 0x0, 0x0, 0x0
.long 0x3c003c00, 0x0, 0x0, 0x0
.long 0x3c003c00, 0x3c00, 0x0, 0x0
.long 0x0, 0x0, 0x3c003c00, 0x3c003c00
.long 0x0, 0x0, 0x3c000000, 0x3c003c00
.long 0x0, 0x0, 0x0, 0x3c003c00
.long 0x0, 0x0, 0x0, 0x3c000000
.long 0x0, 0x0, 0x0, 0x0
.long 0x0, 0x0, 0x0, 0x0
.long 0x0, 0x0, 0x0, 0x0
.long 0x0, 0x0, 0x0, 0x0
.long 0x0, 0x0, 0x0, 0x0
.long 0x0, 0x0, 0x0, 0x0
.long 0x0, 0x0, 0x0, 0x0
.long 0x0, 0x0, 0x0, 0x0
.long 0x0, 0x0, 0x0, 0x0
.long 0x0, 0x0, 0x0, 0x0
.long 0x0, 0x0, 0x0, 0x0
.long 0x0, 0x0, 0x0, 0x0
.long 0x3c003c00, 0x3c003c00, 0x3c00, 0x0
.long 0x3c003c00, 0x3c003c00, 0x3c003c00, 0x0
.long 0x3c003c00, 0x3c003c00, 0x3c003c00, 0x3c00
.long 0x3c003c00, 0x3c003c00, 0x3c003c00, 0x3c003c00
.long 0x3c003c00, 0x3c003c00, 0x3c003c00, 0x3c003c00
.long 0x3c000000, 0x3c003c00, 0x3c003c00, 0x3c003c00
.long 0x0, 0x3c003c00, 0x3c003c00, 0x3c003c00
.long 0x0, 0x3c000000, 0x3c003c00, 0x3c003c00
.long 0x0, 0x0, 0x3c003c00, 0x3c003c00
.long 0x0, 0x0, 0x3c000000, 0x3c003c00
.long 0x0, 0x0, 0x0, 0x3c003c00
.long 0x0, 0x0, 0x0, 0x3c000000
.long 0x0, 0x0, 0x0, 0x0
.long 0x0, 0x0, 0x0, 0x0
.long 0x0, 0x0, 0x0, 0x0
.long 0x0, 0x0, 0x0, 0x0
.long 0x0, 0x0, 0x0, 0x0
.long 0x0, 0x0, 0x0, 0x0
.long 0x0, 0x0, 0x0, 0x0
.long 0x0, 0x0, 0x0, 0x0
.long 0x3c00, 0x0, 0x0, 0x0
.long 0x3c003c00, 0x0, 0x0, 0x0
.long 0x3c003c00, 0x3c00, 0x0, 0x0
.long 0x3c003c00, 0x3c003c00, 0x0, 0x0
.long 0x3c003c00, 0x3c003c00, 0x3c00, 0x0
.long 0x3c003c00, 0x3c003c00, 0x3c003c00, 0x0
.long 0x3c003c00, 0x3c003c00, 0x3c003c00, 0x3c00
.long 0x3c003c00, 0x3c003c00, 0x3c003c00, 0x3c003c00
.long 0x3c003c00, 0x3c003c00, 0x3c003c00, 0x3c003c00
.long 0x3c000000, 0x3c003c00, 0x3c003c00, 0x3c003c00
.long 0x0, 0x3c003c00, 0x3c003c00, 0x3c003c00
.long 0x0, 0x3c000000, 0x3c003c00, 0x3c003c00
.long 0x0, 0x0, 0x0, 0x0
.long 0x0, 0x0, 0x0, 0x0
.long 0x0, 0x0, 0x0, 0x0
.long 0x0, 0x0, 0x0, 0x0
.long 0x0, 0x0, 0x0, 0x0
.long 0x0, 0x0, 0x0, 0x0
.long 0x0, 0x0, 0x0, 0x0
.long 0x0, 0x0, 0x0, 0x0
.long 0x0, 0x0, 0x0, 0x0
.long 0x0, 0x0, 0x0, 0x0
.long 0x0, 0x0, 0x0, 0x0
.long 0x0, 0x0, 0x0, 0x0
.long 0x3c00, 0x0, 0x0, 0x0
.long 0x3c003c00, 0x0, 0x0, 0x0
.long 0x3c003c00, 0x3c00, 0x0, 0x0
.long 0x3c003c00, 0x3c003c00, 0x0, 0x0
.long 0x0, 0x0, 0x0, 0x0
.long 0x0, 0x0, 0x0, 0x0
.long 0x0, 0x0, 0x0, 0x0
.long 0x0, 0x0, 0x0, 0x0
.long 0x0, 0x0, 0x0, 0x0
.long 0x0, 0x0, 0x0, 0x0
.long 0x0, 0x0, 0x0, 0x0
.long 0x0, 0x0, 0x0, 0x0
.long 0x0, 0x0, 0x0, 0x0
.long 0x0, 0x0, 0x0, 0x0
.long 0x0, 0x0, 0x0, 0x0
.long 0x0, 0x0, 0x0, 0x0
.long 0x0, 0x0, 0x0, 0x0
.long 0x0, 0x0, 0x0, 0x0
.long 0x0, 0x0, 0x0, 0x0
.long 0x0, 0x0, 0x0, 0x0
.long 0x0, 0x0, 0x10001, 0x0
.long 0x0, 0x0, 0x10000, 0x1
.long 0x0, 0x0, 0x0, 0x10001
.long 0x0, 0x0, 0x0, 0x10000
.long 0x0, 0x0, 0x0, 0x0
.long 0x0, 0x0, 0x0, 0x0
.long 0x0, 0x0, 0x0, 0x0
.long 0x0, 0x0, 0x0, 0x0
.long 0x0, 0x0, 0x0, 0x0
.long 0x0, 0x0, 0x0, 0x0
.long 0x0, 0x0, 0x0, 0x0
.long 0x0, 0x0, 0x0, 0x0
.long 0x0, 0x0, 0x0, 0x0
.long 0x0, 0x0, 0x0, 0x0
.long 0x0, 0x0, 0x0, 0x0
.long 0x0, 0x0, 0x0, 0x0
.long 0x0, 0x0, 0x0, 0x0
.long 0x0, 0x0, 0x0, 0x0
.long 0x0, 0x0, 0x0, 0x0
.long 0x1, 0x0, 0x0, 0x0
.long 0x10001, 0x0, 0x0, 0x0
.long 0x10000, 0x1, 0x0, 0x0
.long 0x0, 0x10001, 0x0, 0x0
.long 0x0, 0x10000, 0x1, 0x0
.long 0x0, 0x0, 0x10001, 0x0
.long 0x0, 0x0, 0x10000, 0x1
.long 0x0, 0x0, 0x0, 0x10001
.long 0x0, 0x0, 0x0, 0x10000
.long 0x0, 0x0, 0x0, 0x0
.long 0x0, 0x0, 0x0, 0x0
.long 0x0, 0x0, 0x0, 0x0
.long 0x0, 0x0, 0x0, 0x0
.long 0x0, 0x0, 0x0, 0x0
.long 0x0, 0x0, 0x0, 0x0
.long 0x0, 0x0, 0x0, 0x0
.long 0x0, 0x0, 0x0, 0x0
.long 0x0, 0x0, 0x0, 0x0
.long 0x0, 0x0, 0x0, 0x0
.long 0x0, 0x0, 0x0, 0x0
.long 0x0, 0x0, 0x0, 0x0
.long 0x0, 0x0, 0x0, 0x0
.long 0x0, 0x0, 0x0, 0x0
.long 0x0, 0x0, 0x0, 0x0
.long 0x1, 0x0, 0x0, 0x0
.long 0x10001, 0x0, 0x0, 0x0
.long 0x10000, 0x1, 0x0, 0x0
.long 0x0, 0x10001, 0x0, 0x0
.long 0x0, 0x10000, 0x1, 0x0
.globl k3_kernel
.p2align 8
.type k3_kernel,@function
k3_kernel:
  s_cmp_ge_u32 s2, 288
  s_cbranch_scc1 K3_END
  s_load_dwordx2 s[12:13], s[0:1], 112
  s_load_dwordx2 s[16:17], s[0:1], 96
  s_load_dwordx2 s[20:21], s[0:1], 48
  v_lshrrev_b32 v1, 6, v0
  s_nop 0
  v_readfirstlane_b32 s3, v1
  s_mov_b32 s14, 25165824
  s_mov_b32 s15, 0x20000
  s_mov_b32 s18, 4194304
  s_mov_b32 s19, 0x20000
  s_mov_b32 s22, 2048
  s_mov_b32 s23, 0x20000
  s_waitcnt lgkmcnt(0)
  s_cmp_lt_u32 s2, 32
  s_cbranch_scc1 K3_ROW
  s_add_u32 s4, s2, 0
  s_sub_u32 s4, s4, 32
  s_and_b32 s5, s4, 7
  s_lshr_b32 s6, s4, 3
  s_lshl_b32 s7, s5, 19
  s_lshl_b32 s8, s6, 7
  s_add_u32 s7, s7, s8
  s_add_u32 s7, s7, 10485760
  s_add_u32 s8, s7, 8192
  v_and_b32 v2, 31, v0
  v_lshrrev_b32 v3, 5, v0
  v_lshlrev_b32 v4, 14, v2
  v_lshl_add_u32 v4, v3, 4, v4
  v_add_u32 v5, 4096, v4
  v_mov_b32 v6, 0
  s_mov_b32 s9, 8394752
  buffer_load_dwordx4 v[8:11], v4, s[12:15], s7 offen
  buffer_load_dwordx4 v[12:15], v5, s[12:15], s7 offen
  buffer_load_dwordx4 v[16:19], v4, s[12:15], s8 offen
  buffer_load_dwordx4 v[20:23], v5, s[12:15], s8 offen
  buffer_load_dword v7, v6, s[12:15], s9 offen
  s_lshl_b32 s7, s6, 17
  s_lshl_b32 s8, s5, 8
  s_add_u32 s7, s7, s8
  s_add_u32 s8, s7, 4096
  s_add_u32 s9, s7, 8192
  s_add_u32 s10, s7, 12288
  v_lshlrev_b32 v4, 14, v3
  v_lshl_add_u32 v4, v2, 3, v4
  s_mov_b32 s24, 0x05040100
  s_mov_b32 s25, 0x07060302
  s_lshl_b32 s11, s6, 6
  v_lshlrev_b32 v5, 3, v3
  v_add_u32 v5, s11, v5
  v_mov_b32 v6, 0x7ffffff0
  s_waitcnt vmcnt(0)
  v_and_b32 v7, 0xffff, v7
  v_sub_u32 v7, 2047, v7
  v_sub_u32 v7, v7, v5
  v_perm_b32 v24, v12, v8, s24
  v_perm_b32 v25, v20, v16, s24
  v_cmp_eq_u32 vcc, 0, v7
  s_nop 1
  v_cndmask_b32 v40, v4, v6, vcc
  v_perm_b32 v26, v12, v8, s25
  v_perm_b32 v27, v20, v16, s25
  v_cmp_eq_u32 vcc, 1, v7
  s_nop 1
  v_cndmask_b32 v41, v4, v6, vcc
  v_perm_b32 v28, v13, v9, s24
  v_perm_b32 v29, v21, v17, s24
  v_cmp_eq_u32 vcc, 2, v7
  s_nop 1
  v_cndmask_b32 v42, v4, v6, vcc
  v_perm_b32 v30, v13, v9, s25
  v_perm_b32 v31, v21, v17, s25
  v_cmp_eq_u32 vcc, 3, v7
  s_nop 1
  v_cndmask_b32 v43, v4, v6, vcc
  v_perm_b32 v32, v14, v10, s24
  v_perm_b32 v33, v22, v18, s24
  v_cmp_eq_u32 vcc, 4, v7
  s_nop 1
  v_cndmask_b32 v44, v4, v6, vcc
  v_perm_b32 v34, v14, v10, s25
  v_perm_b32 v35, v22, v18, s25
  v_cmp_eq_u32 vcc, 5, v7
  s_nop 1
  v_cndmask_b32 v45, v4, v6, vcc
  v_perm_b32 v36, v15, v11, s24
  v_perm_b32 v37, v23, v19, s24
  v_cmp_eq_u32 vcc, 6, v7
  s_nop 1
  v_cndmask_b32 v46, v4, v6, vcc
  v_perm_b32 v38, v15, v11, s25
  v_perm_b32 v39, v23, v19, s25
  v_cmp_eq_u32 vcc, 7, v7
  s_nop 1
  v_cndmask_b32 v47, v4, v6, vcc
  buffer_store_dwordx2 v[24:25], v40, s[16:19], s7 offen offset:0 sc1
  buffer_store_dwordx2 v[26:27], v41, s[16:19], s7 offen offset:2048 sc1
  buffer_store_dwordx2 v[28:29], v42, s[16:19], s8 offen offset:0 sc1
  buffer_store_dwordx2 v[30:31], v43, s[16:19], s8 offen offset:2048 sc1
  buffer_store_dwordx2 v[32:33], v44, s[16:19], s9 offen offset:0 sc1
  buffer_store_dwordx2 v[34:35], v45, s[16:19], s9 offen offset:2048 sc1
  buffer_store_dwordx2 v[36:37], v46, s[16:19], s10 offen offset:0 sc1
  buffer_store_dwordx2 v[38:39], v47, s[16:19], s10 offen offset:2048 sc1
  s_endpgm
K3_ROW:
  v_and_b32 v2, 7, v0
  v_lshrrev_b32 v3, 3, v0
  v_lshlrev_b32 v4, 12, v3
  v_lshl_add_u32 v4, v2, 4, v4
  s_lshl_b32 s4, s2, 7
  s_add_u32 s4, s4, 7340032
  buffer_load_dwordx4 v[8:11], v4, s[12:15], s4 offen
  s_add_u32 s4, s4, 131072
  buffer_load_dwordx4 v[12:15], v4, s[12:15], s4 offen
  s_add_u32 s4, s4, 131072
  buffer_load_dwordx4 v[16:19], v4, s[12:15], s4 offen
  s_add_u32 s4, s4, 131072
  buffer_load_dwordx4 v[20:23], v4, s[12:15], s4 offen
  s_add_u32 s4, s4, 131072
  buffer_load_dwordx4 v[24:27], v4, s[12:15], s4 offen
  s_add_u32 s4, s4, 131072
  buffer_load_dwordx4 v[28:31], v4, s[12:15], s4 offen
  s_add_u32 s4, s4, 131072
  buffer_load_dwordx4 v[32:35], v4, s[12:15], s4 offen
  v_and_b32 v5, 31, v0
  v_lshlrev_b32 v5, 1, v5
  s_lshl_b32 s5, s2, 6
  s_add_u32 s6, s5, 8388608
  s_add_u32 s7, s6, 4096
  v_mov_b32 v6, 0
  buffer_load_ushort v40, v5, s[12:15], s6 offen
  buffer_load_ushort v41, v5, s[12:15], s6 offen offset:2048
  buffer_load_ushort v42, v5, s[12:15], s7 offen
  buffer_load_ushort v43, v5, s[20:23], s5 offen
  s_mov_b32 s7, 8394752
  buffer_load_dword v44, v6, s[12:15], s7 offen
  s_waitcnt vmcnt(10)
  v_add_f32 v8, v8, v12
  v_add_f32 v9, v9, v13
  v_add_f32 v10, v10, v14
  v_add_f32 v11, v11, v15
  s_waitcnt vmcnt(9)
  v_add_f32 v8, v8, v16
  v_add_f32 v9, v9, v17
  v_add_f32 v10, v10, v18
  v_add_f32 v11, v11, v19
  s_waitcnt vmcnt(8)
  v_add_f32 v8, v8, v20
  v_add_f32 v9, v9, v21
  v_add_f32 v10, v10, v22
  v_add_f32 v11, v11, v23
  s_waitcnt vmcnt(7)
  v_add_f32 v8, v8, v24
  v_add_f32 v9, v9, v25
  v_add_f32 v10, v10, v26
  v_add_f32 v11, v11, v27
  s_waitcnt vmcnt(6)
  v_add_f32 v8, v8, v28
  v_add_f32 v9, v9, v29
  v_add_f32 v10, v10, v30
  v_add_f32 v11, v11, v31
  s_waitcnt vmcnt(5)
  v_add_f32 v8, v8, v32
  v_add_f32 v9, v9, v33
  v_add_f32 v10, v10, v34
  v_add_f32 v11, v11, v35
  v_lshlrev_b32 v7, 4, v0
  ds_write_b128 v7, v[8:11]
  s_waitcnt lgkmcnt(0)
  s_barrier
  s_cmp_lg_u32 s3, 0
  s_cbranch_scc1 K3_END
  v_and_b32 v7, 31, v0
  v_lshlrev_b32 v7, 2, v7
  v_lshrrev_b32 v1, 5, v0
  v_lshl_add_u32 v7, v1, 11, v7
  ds_read_b32 v8, v7 offset:0
  ds_read_b32 v9, v7 offset:128
  ds_read_b32 v10, v7 offset:256
  ds_read_b32 v11, v7 offset:384
  ds_read_b32 v12, v7 offset:512
  ds_read_b32 v13, v7 offset:640
  ds_read_b32 v14, v7 offset:768
  ds_read_b32 v15, v7 offset:896
  ds_read_b32 v16, v7 offset:1024
  ds_read_b32 v17, v7 offset:1152
  ds_read_b32 v18, v7 offset:1280
  ds_read_b32 v19, v7 offset:1408
  ds_read_b32 v20, v7 offset:1536
  ds_read_b32 v21, v7 offset:1664
  ds_read_b32 v22, v7 offset:1792
  ds_read_b32 v23, v7 offset:1920
  s_waitcnt lgkmcnt(0)
  v_add_f32 v8, v8, v16
  v_add_f32 v9, v9, v17
  v_add_f32 v10, v10, v18
  v_add_f32 v11, v11, v19
  v_add_f32 v12, v12, v20
  v_add_f32 v13, v13, v21
  v_add_f32 v14, v14, v22
  v_add_f32 v15, v15, v23
  v_add_f32 v8, v8, v12
  v_add_f32 v9, v9, v13
  v_add_f32 v10, v10, v14
  v_add_f32 v11, v11, v15
  v_add_f32 v8, v8, v10
  v_add_f32 v9, v9, v11
  v_add_f32 v8, v8, v9
  v_mov_b32 v9, v8
  s_nop 1
  v_permlane32_swap_b32 v8, v9
  v_add_f32 v8, v8, v9
  s_waitcnt vmcnt(0)
  v_readfirstlane_b32 s8, v44
  s_nop 0
  s_and_b32 s9, s8, 0xffff
  s_sub_u32 s9, 2047, s9
  s_lshr_b32 s8, s8, 16
  s_xor_b32 s10, s8, 0xffff
  s_and_b32 s11, s8, 0x7fff
  s_cmp_ge_u32 s8, 0x8000
  s_cselect_b32 s8, s11, s10
  s_lshl_b32 s8, s8, 16
  v_mov_b32 v10, s8
  v_mul_f32 v10, 0xbfb8aa3b, v10
  v_exp_f32 v10, v10
  s_nop 0
  v_add_f32 v10, 1.0, v10
  v_rcp_f32 v10, v10
  s_nop 0
  v_cvt_pk_bf16_f32 v11, v8, v10
  v_lshlrev_b32 v8, 16, v11
  v_and_b32 v10, 0xffff0000, v11
  v_mul_f32 v8, v8, v10
  v_lshlrev_b32 v40, 16, v40
  v_lshlrev_b32 v41, 16, v41
  v_lshlrev_b32 v42, 16, v42
  v_lshlrev_b32 v43, 16, v43
  v_mul_f32 v12, v42, v43
  v_cvt_pk_bf16_f32 v11, v8, v12
  v_lshlrev_b32 v8, 16, v11
  v_and_b32 v12, 0xffff0000, v11
  v_add_f32 v8, v42, v8
  v_add_f32 v12, v40, v12
  v_cvt_pk_bf16_f32 v11, v8, v12
  v_lshlrev_b32 v8, 16, v11
  v_and_b32 v12, 0xffff0000, v11
  v_add_f32 v12, v41, v12
  v_cvt_pk_bf16_f32 v11, v12, v12
  v_lshlrev_b32 v12, 16, v11
  v_add_f32 v12, v12, v8
  v_cvt_pk_bf16_f32 v11, v12, v12
  s_lshl_b32 s9, s9, 11
  s_add_u32 s9, s9, s5
  s_mov_b32 s10, -1
  s_mov_b32 s11, 0
  s_mov_b64 exec, s[10:11]
  buffer_store_short v11, v5, s[16:19], s9 offen
  s_mov_b64 exec, -1
K3_END:
  s_endpgm
CODE_END:
.section .rodata,"a"
.p2align 6
.amdhsa_kernel k1_kernel
  .amdhsa_next_free_vgpr 256
  .amdhsa_next_free_sgpr 96
  .amdhsa_accum_offset 256
  .amdhsa_group_segment_fixed_size 0
  .amdhsa_kernarg_size 120
  .amdhsa_user_sgpr_count 2
  .amdhsa_user_sgpr_kernarg_segment_ptr 1
  .amdhsa_system_sgpr_workgroup_id_x 1
  .amdhsa_float_denorm_mode_32 3
.end_amdhsa_kernel
.p2align 6
.amdhsa_kernel k2_kernel
  .amdhsa_next_free_vgpr 168
  .amdhsa_next_free_sgpr 96
  .amdhsa_accum_offset 168
  .amdhsa_group_segment_fixed_size 0
  .amdhsa_kernarg_size 120
  .amdhsa_user_sgpr_count 2
  .amdhsa_user_sgpr_kernarg_segment_ptr 1
  .amdhsa_system_sgpr_workgroup_id_x 1
  .amdhsa_float_denorm_mode_32 3
.end_amdhsa_kernel
.p2align 6
.amdhsa_kernel k3_kernel
  .amdhsa_next_free_vgpr 64
  .amdhsa_next_free_sgpr 96
  .amdhsa_accum_offset 64
  .amdhsa_group_segment_fixed_size 0
  .amdhsa_kernarg_size 120
  .amdhsa_user_sgpr_count 2
  .amdhsa_user_sgpr_kernarg_segment_ptr 1
  .amdhsa_system_sgpr_workgroup_id_x 1
  .amdhsa_float_denorm_mode_32 3
.end_amdhsa_kernel
```
